```python
import torch

def _softmax(x, axis=-1):
    return torch.softmax(x, dim=axis)
def _gelu(x):
    return torch.nn.functional.gelu(x, approximate="tanh")
def _silu(x):
    return torch.nn.functional.silu(x)
def _sigmoid(x):
    return torch.sigmoid(x)
def _layernorm(x, axis=-1, eps=1e-5):
    m = x.mean(dim=axis, keepdim=True)
    v = x.var(dim=axis, keepdim=True, unbiased=False)
    return (x - m) / torch.sqrt(v + eps)
def _scatter_add(tgt, idx, src, axis=0):
    return tgt.clone().index_add_(axis, idx, src)
def _segment_sum(src, seg, n):
    out = torch.zeros((n,) + src.shape[1:], dtype=src.dtype)
    return out.index_add_(0, seg, src)
def _pad(x, pw):
    flat = tuple(v for pair in reversed(pw) for v in pair)
    return torch.nn.functional.pad(x, flat)

kernel_name = 'gated_mix__softmax_full_mha__spectral_fnet__prompt'

def setup_inputs():

    _w = (lambda a: (lambda t: t.to(torch.bfloat16) if t.is_floating_point() else t)(torch.as_tensor(a)))
    def _A_setup():
        B, S, D = 1, 2048, 512
        return {
            "x": _w((lambda *s: torch.randn(*s, dtype=torch.bfloat16) * 0.05)(B, S, D)),
            "wqkv": _w((lambda *s: torch.randn(*s, dtype=torch.bfloat16) * 1.6)(D, 3 * D)),
            "wo": _w((lambda *s: torch.randn(*s, dtype=torch.bfloat16) * 1.6)(D, D)),
        }
    _A_in = _A_setup()

    def _B_setup():
        B, S, D = 1, 2048, 512
        ns = torch.arange(S)[:, None] * torch.arange(S)[None, :]
        nd = torch.arange(D)[:, None] * torch.arange(D)[None, :]
        Ws_re = torch.cos(-2.0 * torch.pi * ns / S).to(float)
        Ws_im = torch.sin(-2.0 * torch.pi * ns / S).to(float)
        Wd_re = torch.cos(-2.0 * torch.pi * nd / D).to(float)
        Wd_im = torch.sin(-2.0 * torch.pi * nd / D).to(float)
        return {
            "x": _w((lambda *s: torch.randn(*s, dtype=torch.bfloat16) * 0.05)(B, S, D)),
            "dft_seq_re": _w(Ws_re),
            "dft_seq_im": _w(Ws_im),
            "dft_hid_re": _w(Wd_re),
            "dft_hid_im": _w(Wd_im),
        }
    _B_in = _B_setup()

    return {
        "A_x": _A_in["x"],
        "A_wqkv": _A_in["wqkv"],
        "A_wo": _A_in["wo"],
        "B_x": _B_in["x"],
        "B_dft_seq_re": _B_in["dft_seq_re"],
        "B_dft_seq_im": _B_in["dft_seq_im"],
        "B_dft_hid_re": _B_in["dft_hid_re"],
        "B_dft_hid_im": _B_in["dft_hid_im"],
        "gate_w": _w((lambda *s: torch.randn(*s, dtype=torch.bfloat16) * 0.05)(512) * 16.0),
    }

def reference(A_x, A_wqkv, A_wo, B_x, B_dft_seq_re, B_dft_seq_im, B_dft_hid_re, B_dft_hid_im, gate_w):
    def _A_ref(x, wqkv, wo):
        B, S, D = x.shape
        H = 32; Dh = D // H
        qkv = (lambda x, *d: x.permute(*d))((x @ wqkv).reshape(B, S, 3, H, Dh), 2, 0, 3, 1, 4)
        q, k, v = qkv[0], qkv[1], qkv[2]
        scale = Dh ** -0.5
        scores = torch.einsum("bhqd,bhkd->bhqk", q, k) * scale
        p = _softmax(scores, axis=-1)
        o = torch.einsum("bhqk,bhkd->bhqd", p, v)
        return (lambda x, *d: x.permute(*d))(o, 0, 2, 1, 3).reshape(B, S, D) @ wo

    def _B_ref(x, dft_seq_re, dft_seq_im, dft_hid_re, dft_hid_im):
        a = torch.einsum("bsd,ed->bse", x, dft_hid_re)
        b = torch.einsum("bsd,ed->bse", x, dft_hid_im)
        y = torch.einsum("ts,bse->bte", dft_seq_re, a) - torch.einsum("ts,bse->bte", dft_seq_im, b)
        return y

    x = A_x
    g = _sigmoid((x * gate_w).sum(-1, keepdims=True))
    a = _A_ref(x, A_wqkv, A_wo)
    b = _B_ref(x, B_dft_seq_re, B_dft_seq_im, B_dft_hid_re, B_dft_hid_im)
    return g * a + (1 - g) * b
```

```asm
; @launch grid=(256,1,1) block=(768,1,1) lds=163840
.amdgcn_target "amdgcn-amd-amdhsa--gfx950"
.text
.globl gated_mix__softmax_full_mha__spectral_fnet__prompt_kernel
.p2align 8
.type gated_mix__softmax_full_mha__spectral_fnet__prompt_kernel,@function
gated_mix__softmax_full_mha__spectral_fnet__prompt_kernel:

    s_cmp_ge_u32 s2, 256
    s_cbranch_scc1 gated_mix__softmax_full_mha__spectral_fnet__prompt_kernel_end
    s_load_dwordx16 s[4:19], s[0:1], 0
    s_load_dwordx8 s[20:27], s[0:1], 64
    v_lshrrev_b32 v3, 6, v0
    v_and_b32 v1, 63, v0
    v_readfirstlane_b32 s28, v3
    v_lshlrev_b32 v2, 4, v1
    s_cmp_ge_u32 s2, 192
    s_cselect_b32 s30, 1, 0
    s_cbranch_scc1 gated_mix__softmax_full_mha__spectral_fnet__prompt_kernel_decF
    s_and_b32 s48, s2, 7
    s_lshr_b32 s49, s2, 3
    s_lshr_b32 s50, s48, 1
    s_lshl_b32 s50, s50, 2
    s_and_b32 s52, s49, 3
    s_add_u32 s52, s52, s50
    s_and_b32 s48, s48, 1
    s_mul_i32 s48, s48, 6
    s_lshr_b32 s54, s49, 2
    s_add_u32 s54, s54, s48
    s_lshl_b32 s62, s54, 4
    s_add_u32 s62, s62, s52
    s_lshl_b32 s52, s52, 7
    s_lshl_b32 s53, s54, 7
    s_branch gated_mix__softmax_full_mha__spectral_fnet__prompt_kernel_dec
gated_mix__softmax_full_mha__spectral_fnet__prompt_kernel_decF:
    s_sub_u32 s48, s2, 192
    s_add_u32 s62, s48, 256
    s_lshr_b32 s49, s48, 3
    s_lshr_b32 s55, s49, 2
    s_and_b32 s49, s49, 3
    s_and_b32 s54, s48, 1
    s_bfe_u32 s50, s48, 0x20001
    s_lshl_b32 s51, s50, 3
    s_lshr_b32 s51, 0x040c0800, s51
    s_and_b32 s51, s51, 0xff
    s_add_u32 s49, s49, s51
    s_lshl_b32 s52, s49, 6
    s_lshl_b32 s53, s54, 7
gated_mix__softmax_full_mha__spectral_fnet__prompt_kernel_dec:
    s_cmp_ge_u32 s28, 8
    s_cbranch_scc1 gated_mix__softmax_full_mha__spectral_fnet__prompt_kernel_edge
    s_cmp_lt_u32 s28, 4
    s_cbranch_scc1 gated_mix__softmax_full_mha__spectral_fnet__prompt_kernel_cons
    s_sub_u32 s63, s28, 4
    v_lshrrev_b32 v3, 3, v1
    v_lshlrev_b32 v3, 10, v3
    v_lshrrev_b32 v4, 4, v1
    v_and_b32 v5, 7, v1
    v_add_u32 v6, 0, v4
    v_xor_b32 v6, v6, v5
    v_lshlrev_b32 v6, 4, v6
    v_add_u32 v7, v3, v6
    v_add_u32 v6, 4, v4
    v_xor_b32 v6, v6, v5
    v_lshlrev_b32 v6, 4, v6
    v_add_u32 v8, v3, v6
    s_cmp_lg_u32 s30, 0
    s_cbranch_scc1 gated_mix__softmax_full_mha__spectral_fnet__prompt_kernel_lF
    v_lshrrev_b32 v3, 4, v1
    v_mul_u32_u24 v4, 3072, v3
    v_bfe_u32 v5, v1, 2, 2
    v_xor_b32 v5, v5, v3
    v_lshlrev_b32 v5, 6, v5
    v_add_u32 v4, v4, v5
    v_and_b32 v5, 3, v1
    v_lshlrev_b32 v5, 4, v5
    v_add_u32 v9, v4, v5
    s_lshl_b32 s48, s63, 5
    s_add_u32 s48, s48, s52
    s_lshl_b32 s58, s48, 10
    s_mul_i32 s59, s63, 49152
    s_lshl_b32 s48, s53, 1
    s_add_u32 s59, s59, s48
    s_lshl_b32 s60, s63, 12
    s_add_u32 s61, s60, 16384
    s_waitcnt lgkmcnt(0)
    s_mov_b32 s36, s4
    s_and_b32 s37, s5, 0xffff
    s_mov_b32 s38, 2097152
    s_mov_b32 s39, 0x00020000
    s_mov_b32 s40, s6
    s_and_b32 s41, s7, 0xffff
    s_mov_b32 s42, 1572864
    s_mov_b32 s43, 0x00020000
    s_add_u32 m0, s60, 0
    s_add_u32 s48, s58, 0
    buffer_load_dwordx4 v7, s[36:39], s48 offen lds
    s_add_u32 m0, s61, 0
    s_add_u32 s48, s59, 0
    buffer_load_dwordx4 v9, s[40:43], s48 offen lds
    s_add_u32 m0, s60, 1024
    s_add_u32 s48, s58, 8192
    buffer_load_dwordx4 v8, s[36:39], s48 offen lds
    s_add_u32 m0, s61, 1024
    s_add_u32 s48, s59, 12288
    buffer_load_dwordx4 v9, s[40:43], s48 offen lds
    s_add_u32 m0, s60, 2048
    s_add_u32 s48, s58, 16384
    buffer_load_dwordx4 v7, s[36:39], s48 offen lds
    s_add_u32 m0, s61, 2048
    s_add_u32 s48, s59, 24576
    buffer_load_dwordx4 v9, s[40:43], s48 offen lds
    s_add_u32 m0, s60, 3072
    s_add_u32 s48, s58, 24576
    buffer_load_dwordx4 v8, s[36:39], s48 offen lds
    s_add_u32 m0, s61, 3072
    s_add_u32 s48, s59, 36864
    buffer_load_dwordx4 v9, s[40:43], s48 offen lds
    s_add_u32 m0, s60, 32768
    s_add_u32 s48, s58, 128
    buffer_load_dwordx4 v7, s[36:39], s48 offen lds
    s_add_u32 m0, s61, 32768
    s_add_u32 s48, s59, 196608
    buffer_load_dwordx4 v9, s[40:43], s48 offen lds
    s_add_u32 m0, s60, 33792
    s_add_u32 s48, s58, 8320
    buffer_load_dwordx4 v8, s[36:39], s48 offen lds
    s_add_u32 m0, s61, 33792
    s_add_u32 s48, s59, 208896
    buffer_load_dwordx4 v9, s[40:43], s48 offen lds
    s_add_u32 m0, s60, 34816
    s_add_u32 s48, s58, 16512
    buffer_load_dwordx4 v7, s[36:39], s48 offen lds
    s_add_u32 m0, s61, 34816
    s_add_u32 s48, s59, 221184
    buffer_load_dwordx4 v9, s[40:43], s48 offen lds
    s_add_u32 m0, s60, 35840
    s_add_u32 s48, s58, 24704
    buffer_load_dwordx4 v8, s[36:39], s48 offen lds
    s_add_u32 m0, s61, 35840
    s_add_u32 s48, s59, 233472
    buffer_load_dwordx4 v9, s[40:43], s48 offen lds
    s_waitcnt vmcnt(8)
    s_barrier
    s_add_u32 m0, s60, 65536
    s_add_u32 s48, s58, 256
    buffer_load_dwordx4 v7, s[36:39], s48 offen lds
    s_add_u32 m0, s61, 65536
    s_add_u32 s48, s59, 393216
    buffer_load_dwordx4 v9, s[40:43], s48 offen lds
    s_add_u32 m0, s60, 66560
    s_add_u32 s48, s58, 8448
    buffer_load_dwordx4 v8, s[36:39], s48 offen lds
    s_add_u32 m0, s61, 66560
    s_add_u32 s48, s59, 405504
    buffer_load_dwordx4 v9, s[40:43], s48 offen lds
    s_add_u32 m0, s60, 67584
    s_add_u32 s48, s58, 16640
    buffer_load_dwordx4 v7, s[36:39], s48 offen lds
    s_add_u32 m0, s61, 67584
    s_add_u32 s48, s59, 417792
    buffer_load_dwordx4 v9, s[40:43], s48 offen lds
    s_add_u32 m0, s60, 68608
    s_add_u32 s48, s58, 24832
    buffer_load_dwordx4 v8, s[36:39], s48 offen lds
    s_add_u32 m0, s61, 68608
    s_add_u32 s48, s59, 430080
    buffer_load_dwordx4 v9, s[40:43], s48 offen lds
    s_add_u32 m0, s60, 98304
    s_add_u32 s48, s58, 384
    buffer_load_dwordx4 v7, s[36:39], s48 offen lds
    s_add_u32 m0, s61, 98304
    s_add_u32 s48, s59, 589824
    buffer_load_dwordx4 v9, s[40:43], s48 offen lds
    s_add_u32 m0, s60, 99328
    s_add_u32 s48, s58, 8576
    buffer_load_dwordx4 v8, s[36:39], s48 offen lds
    s_add_u32 m0, s61, 99328
    s_add_u32 s48, s59, 602112
    buffer_load_dwordx4 v9, s[40:43], s48 offen lds
    s_waitcnt vmcnt(12)
    s_barrier
    s_add_u32 m0, s60, 100352
    s_add_u32 s48, s58, 16768
    buffer_load_dwordx4 v7, s[36:39], s48 offen lds
    s_add_u32 m0, s61, 100352
    s_add_u32 s48, s59, 614400
    buffer_load_dwordx4 v9, s[40:43], s48 offen lds
    s_add_u32 m0, s60, 101376
    s_add_u32 s48, s58, 24960
    buffer_load_dwordx4 v8, s[36:39], s48 offen lds
    s_add_u32 m0, s61, 101376
    s_add_u32 s48, s59, 626688
    buffer_load_dwordx4 v9, s[40:43], s48 offen lds
    s_waitcnt vmcnt(8)
    s_barrier
    s_add_u32 m0, s60, 0
    s_add_u32 s48, s58, 512
    buffer_load_dwordx4 v7, s[36:39], s48 offen lds
    s_add_u32 m0, s61, 0
    s_add_u32 s48, s59, 786432
    buffer_load_dwordx4 v9, s[40:43], s48 offen lds
    s_add_u32 m0, s60, 1024
    s_add_u32 s48, s58, 8704
    buffer_load_dwordx4 v8, s[36:39], s48 offen lds
    s_add_u32 m0, s61, 1024
    s_add_u32 s48, s59, 798720
    buffer_load_dwordx4 v9, s[40:43], s48 offen lds
    s_add_u32 m0, s60, 2048
    s_add_u32 s48, s58, 16896
    buffer_load_dwordx4 v7, s[36:39], s48 offen lds
    s_add_u32 m0, s61, 2048
    s_add_u32 s48, s59, 811008
    buffer_load_dwordx4 v9, s[40:43], s48 offen lds
    s_add_u32 m0, s60, 3072
    s_add_u32 s48, s58, 25088
    buffer_load_dwordx4 v8, s[36:39], s48 offen lds
    s_add_u32 m0, s61, 3072
    s_add_u32 s48, s59, 823296
    buffer_load_dwordx4 v9, s[40:43], s48 offen lds
    s_waitcnt vmcnt(8)
    s_barrier
    s_add_u32 m0, s60, 32768
    s_add_u32 s48, s58, 640
    buffer_load_dwordx4 v7, s[36:39], s48 offen lds
    s_add_u32 m0, s61, 32768
    s_add_u32 s48, s59, 983040
    buffer_load_dwordx4 v9, s[40:43], s48 offen lds
    s_add_u32 m0, s60, 33792
    s_add_u32 s48, s58, 8832
    buffer_load_dwordx4 v8, s[36:39], s48 offen lds
    s_add_u32 m0, s61, 33792
    s_add_u32 s48, s59, 995328
    buffer_load_dwordx4 v9, s[40:43], s48 offen lds
    s_add_u32 m0, s60, 34816
    s_add_u32 s48, s58, 17024
    buffer_load_dwordx4 v7, s[36:39], s48 offen lds
    s_add_u32 m0, s61, 34816
    s_add_u32 s48, s59, 1007616
    buffer_load_dwordx4 v9, s[40:43], s48 offen lds
    s_add_u32 m0, s60, 35840
    s_add_u32 s48, s58, 25216
    buffer_load_dwordx4 v8, s[36:39], s48 offen lds
    s_add_u32 m0, s61, 35840
    s_add_u32 s48, s59, 1019904
    buffer_load_dwordx4 v9, s[40:43], s48 offen lds
    s_waitcnt vmcnt(8)
    s_barrier
    s_add_u32 m0, s60, 65536
    s_add_u32 s48, s58, 768
    buffer_load_dwordx4 v7, s[36:39], s48 offen lds
    s_add_u32 m0, s61, 65536
    s_add_u32 s48, s59, 1179648
    buffer_load_dwordx4 v9, s[40:43], s48 offen lds
    s_add_u32 m0, s60, 66560
    s_add_u32 s48, s58, 8960
    buffer_load_dwordx4 v8, s[36:39], s48 offen lds
    s_add_u32 m0, s61, 66560
    s_add_u32 s48, s59, 1191936
    buffer_load_dwordx4 v9, s[40:43], s48 offen lds
    s_add_u32 m0, s60, 67584
    s_add_u32 s48, s58, 17152
    buffer_load_dwordx4 v7, s[36:39], s48 offen lds
    s_add_u32 m0, s61, 67584
    s_add_u32 s48, s59, 1204224
    buffer_load_dwordx4 v9, s[40:43], s48 offen lds
    s_add_u32 m0, s60, 68608
    s_add_u32 s48, s58, 25344
    buffer_load_dwordx4 v8, s[36:39], s48 offen lds
    s_add_u32 m0, s61, 68608
    s_add_u32 s48, s59, 1216512
    buffer_load_dwordx4 v9, s[40:43], s48 offen lds
    s_waitcnt vmcnt(8)
    s_barrier
    s_add_u32 m0, s60, 98304
    s_add_u32 s48, s58, 896
    buffer_load_dwordx4 v7, s[36:39], s48 offen lds
    s_add_u32 m0, s61, 98304
    s_add_u32 s48, s59, 1376256
    buffer_load_dwordx4 v9, s[40:43], s48 offen lds
    s_add_u32 m0, s60, 99328
    s_add_u32 s48, s58, 9088
    buffer_load_dwordx4 v8, s[36:39], s48 offen lds
    s_add_u32 m0, s61, 99328
    s_add_u32 s48, s59, 1388544
    buffer_load_dwordx4 v9, s[40:43], s48 offen lds
    s_add_u32 m0, s60, 100352
    s_add_u32 s48, s58, 17280
    buffer_load_dwordx4 v7, s[36:39], s48 offen lds
    s_add_u32 m0, s61, 100352
    s_add_u32 s48, s59, 1400832
    buffer_load_dwordx4 v9, s[40:43], s48 offen lds
    s_add_u32 m0, s60, 101376
    s_add_u32 s48, s58, 25472
    buffer_load_dwordx4 v8, s[36:39], s48 offen lds
    s_add_u32 m0, s61, 101376
    s_add_u32 s48, s59, 1413120
    buffer_load_dwordx4 v9, s[40:43], s48 offen lds
    s_waitcnt vmcnt(8)
    s_barrier
    s_waitcnt vmcnt(0)
    s_barrier
    s_barrier
    s_branch gated_mix__softmax_full_mha__spectral_fnet__prompt_kernel_attn
gated_mix__softmax_full_mha__spectral_fnet__prompt_kernel_lF:
    s_cmp_eq_u32 s55, 0
    s_cbranch_scc1 gated_mix__softmax_full_mha__spectral_fnet__prompt_kernel_lFa
    s_waitcnt lgkmcnt(0)
    s_mov_b32 s40, s18
    s_and_b32 s41, s19, 0xffff
    s_mov_b32 s42, 524288
    s_mov_b32 s43, 0x00020000
    s_mov_b32 s44, 0x0000bf80
    s_mov_b32 s45, 0xbf800000
    s_branch gated_mix__softmax_full_mha__spectral_fnet__prompt_kernel_lFgo
gated_mix__softmax_full_mha__spectral_fnet__prompt_kernel_lFa:
    s_waitcnt lgkmcnt(0)
    s_mov_b32 s40, s16
    s_and_b32 s41, s17, 0xffff
    s_mov_b32 s42, 524288
    s_mov_b32 s43, 0x00020000
    s_mov_b32 s44, 0x00003f80
    s_mov_b32 s45, 0x3f800000
gated_mix__softmax_full_mha__spectral_fnet__prompt_kernel_lFgo:
    s_mov_b32 s46, 0x00003f80
    s_mov_b32 s47, 0x3f800000
    s_lshl_b32 s48, s63, 4
    s_add_u32 s48, s48, s52
    v_lshrrev_b32 v3, 3, v1
    v_add_u32 v3, s48, v3
    v_add_u32 v4, 0, v3
    v_and_b32 v5, 1023, v7
    v_lshl_add_u32 v10, v4, 10, v5
    v_sub_u32 v4, 2048, v4
    v_lshl_add_u32 v12, v4, 10, v5
    v_add_u32 v4, 8, v3
    v_and_b32 v5, 1023, v8
    v_lshl_add_u32 v11, v4, 10, v5
    v_sub_u32 v4, 2048, v4
    v_lshl_add_u32 v13, v4, 10, v5
    s_lshl_b32 s48, s63, 5
    s_add_u32 s48, s48, s53
    s_lshl_b32 s59, s48, 10
    s_lshl_b32 s61, s63, 12
    s_add_u32 s61, s61, 8192
    s_lshl_b32 s48, s63, 11
    v_add_u32 v14, s48, v2
    s_mov_b32 s36, s4
    s_and_b32 s37, s5, 0xffff
    s_mov_b32 s38, 2097152
    s_mov_b32 s39, 0x00020000
    s_mov_b32 s48, 0
    buffer_load_dwordx4 v[16:19], v10, s[36:39], s48 offen
    buffer_load_dwordx4 v[20:23], v12, s[36:39], s48 offen
    buffer_load_dwordx4 v[24:27], v11, s[36:39], s48 offen
    buffer_load_dwordx4 v[28:31], v13, s[36:39], s48 offen
    s_add_u32 m0, s61, 0
    s_add_u32 s48, s59, 0
    buffer_load_dwordx4 v7, s[40:43], s48 offen lds
    s_add_u32 m0, s61, 1024
    s_add_u32 s48, s59, 8192
    buffer_load_dwordx4 v8, s[40:43], s48 offen lds
    s_add_u32 m0, s61, 2048
    s_add_u32 s48, s59, 16384
    buffer_load_dwordx4 v7, s[40:43], s48 offen lds
    s_add_u32 m0, s61, 3072
    s_add_u32 s48, s59, 24576
    buffer_load_dwordx4 v8, s[40:43], s48 offen lds
    s_mov_b32 s48, 128
    buffer_load_dwordx4 v[32:35], v10, s[36:39], s48 offen
    buffer_load_dwordx4 v[36:39], v12, s[36:39], s48 offen
    buffer_load_dwordx4 v[40:43], v11, s[36:39], s48 offen
    buffer_load_dwordx4 v[44:47], v13, s[36:39], s48 offen
    s_add_u32 m0, s61, 24576
    s_add_u32 s48, s59, 128
    buffer_load_dwordx4 v7, s[40:43], s48 offen lds
    s_add_u32 m0, s61, 25600
    s_add_u32 s48, s59, 8320
    buffer_load_dwordx4 v8, s[40:43], s48 offen lds
    s_add_u32 m0, s61, 26624
    s_add_u32 s48, s59, 16512
    buffer_load_dwordx4 v7, s[40:43], s48 offen lds
    s_add_u32 m0, s61, 27648
    s_add_u32 s48, s59, 24704
    buffer_load_dwordx4 v8, s[40:43], s48 offen lds
    s_mov_b32 s48, 256
    buffer_load_dwordx4 v[48:51], v10, s[36:39], s48 offen
    buffer_load_dwordx4 v[52:55], v12, s[36:39], s48 offen
    buffer_load_dwordx4 v[56:59], v11, s[36:39], s48 offen
    buffer_load_dwordx4 v[60:63], v13, s[36:39], s48 offen
    s_add_u32 m0, s61, 49152
    s_add_u32 s48, s59, 256
    buffer_load_dwordx4 v7, s[40:43], s48 offen lds
    s_add_u32 m0, s61, 50176
    s_add_u32 s48, s59, 8448
    buffer_load_dwordx4 v8, s[40:43], s48 offen lds
    s_add_u32 m0, s61, 51200
    s_add_u32 s48, s59, 16640
    buffer_load_dwordx4 v7, s[40:43], s48 offen lds
    s_add_u32 m0, s61, 52224
    s_add_u32 s48, s59, 24832
    buffer_load_dwordx4 v8, s[40:43], s48 offen lds
    s_waitcnt vmcnt(20)
    v_dot2_f32_bf16 v80, v16, s46, 0
    v_dot2_f32_bf16 v81, v16, s47, 0
    v_dot2_f32_bf16 v82, v17, s46, 0
    v_dot2_f32_bf16 v83, v17, s47, 0
    v_dot2_f32_bf16 v84, v18, s46, 0
    v_dot2_f32_bf16 v85, v18, s47, 0
    v_dot2_f32_bf16 v86, v19, s46, 0
    v_dot2_f32_bf16 v87, v19, s47, 0
    v_dot2c_f32_bf16 v80, s44, v20
    v_dot2c_f32_bf16 v81, s45, v20
    v_dot2c_f32_bf16 v82, s44, v21
    v_dot2c_f32_bf16 v83, s45, v21
    v_dot2c_f32_bf16 v84, s44, v22
    v_dot2c_f32_bf16 v85, s45, v22
    v_dot2c_f32_bf16 v86, s44, v23
    v_dot2c_f32_bf16 v87, s45, v23
    v_cvt_pk_bf16_f32 v16, v80, v81
    v_cvt_pk_bf16_f32 v17, v82, v83
    v_cvt_pk_bf16_f32 v18, v84, v85
    v_cvt_pk_bf16_f32 v19, v86, v87
    ds_write_b128 v14, v[16:19] offset:0
    v_dot2_f32_bf16 v80, v24, s46, 0
    v_dot2_f32_bf16 v81, v24, s47, 0
    v_dot2_f32_bf16 v82, v25, s46, 0
    v_dot2_f32_bf16 v83, v25, s47, 0
    v_dot2_f32_bf16 v84, v26, s46, 0
    v_dot2_f32_bf16 v85, v26, s47, 0
    v_dot2_f32_bf16 v86, v27, s46, 0
    v_dot2_f32_bf16 v87, v27, s47, 0
    v_dot2c_f32_bf16 v80, s44, v28
    v_dot2c_f32_bf16 v81, s45, v28
    v_dot2c_f32_bf16 v82, s44, v29
    v_dot2c_f32_bf16 v83, s45, v29
    v_dot2c_f32_bf16 v84, s44, v30
    v_dot2c_f32_bf16 v85, s45, v30
    v_dot2c_f32_bf16 v86, s44, v31
    v_dot2c_f32_bf16 v87, s45, v31
    v_cvt_pk_bf16_f32 v24, v80, v81
    v_cvt_pk_bf16_f32 v25, v82, v83
    v_cvt_pk_bf16_f32 v26, v84, v85
    v_cvt_pk_bf16_f32 v27, v86, v87
    ds_write_b128 v14, v[24:27] offset:1024
    s_waitcnt vmcnt(16)
    s_waitcnt lgkmcnt(0)
    s_barrier
    s_mov_b32 s48, 384
    buffer_load_dwordx4 v[64:67], v10, s[36:39], s48 offen
    buffer_load_dwordx4 v[68:71], v12, s[36:39], s48 offen
    buffer_load_dwordx4 v[72:75], v11, s[36:39], s48 offen
    buffer_load_dwordx4 v[76:79], v13, s[36:39], s48 offen
    s_add_u32 m0, s61, 73728
    s_add_u32 s48, s59, 384
    buffer_load_dwordx4 v7, s[40:43], s48 offen lds
    s_add_u32 m0, s61, 74752
    s_add_u32 s48, s59, 8576
    buffer_load_dwordx4 v8, s[40:43], s48 offen lds
    s_add_u32 m0, s61, 75776
    s_add_u32 s48, s59, 16768
    buffer_load_dwordx4 v7, s[40:43], s48 offen lds
    s_add_u32 m0, s61, 76800
    s_add_u32 s48, s59, 24960
    buffer_load_dwordx4 v8, s[40:43], s48 offen lds
    s_mov_b32 s48, 512
    buffer_load_dwordx4 v[16:19], v10, s[36:39], s48 offen
    buffer_load_dwordx4 v[20:23], v12, s[36:39], s48 offen
    buffer_load_dwordx4 v[24:27], v11, s[36:39], s48 offen
    buffer_load_dwordx4 v[28:31], v13, s[36:39], s48 offen
    s_add_u32 m0, s61, 98304
    s_add_u32 s48, s59, 512
    buffer_load_dwordx4 v7, s[40:43], s48 offen lds
    s_add_u32 m0, s61, 99328
    s_add_u32 s48, s59, 8704
    buffer_load_dwordx4 v8, s[40:43], s48 offen lds
    s_add_u32 m0, s61, 100352
    s_add_u32 s48, s59, 16896
    buffer_load_dwordx4 v7, s[40:43], s48 offen lds
    s_add_u32 m0, s61, 101376
    s_add_u32 s48, s59, 25088
    buffer_load_dwordx4 v8, s[40:43], s48 offen lds
    s_waitcnt vmcnt(28)
    v_dot2_f32_bf16 v80, v32, s46, 0
    v_dot2_f32_bf16 v81, v32, s47, 0
    v_dot2_f32_bf16 v82, v33, s46, 0
    v_dot2_f32_bf16 v83, v33, s47, 0
    v_dot2_f32_bf16 v84, v34, s46, 0
    v_dot2_f32_bf16 v85, v34, s47, 0
    v_dot2_f32_bf16 v86, v35, s46, 0
    v_dot2_f32_bf16 v87, v35, s47, 0
    v_dot2c_f32_bf16 v80, s44, v36
    v_dot2c_f32_bf16 v81, s45, v36
    v_dot2c_f32_bf16 v82, s44, v37
    v_dot2c_f32_bf16 v83, s45, v37
    v_dot2c_f32_bf16 v84, s44, v38
    v_dot2c_f32_bf16 v85, s45, v38
    v_dot2c_f32_bf16 v86, s44, v39
    v_dot2c_f32_bf16 v87, s45, v39
    v_cvt_pk_bf16_f32 v32, v80, v81
    v_cvt_pk_bf16_f32 v33, v82, v83
    v_cvt_pk_bf16_f32 v34, v84, v85
    v_cvt_pk_bf16_f32 v35, v86, v87
    ds_write_b128 v14, v[32:35] offset:24576
    v_dot2_f32_bf16 v80, v40, s46, 0
    v_dot2_f32_bf16 v81, v40, s47, 0
    v_dot2_f32_bf16 v82, v41, s46, 0
    v_dot2_f32_bf16 v83, v41, s47, 0
    v_dot2_f32_bf16 v84, v42, s46, 0
    v_dot2_f32_bf16 v85, v42, s47, 0
    v_dot2_f32_bf16 v86, v43, s46, 0
    v_dot2_f32_bf16 v87, v43, s47, 0
    v_dot2c_f32_bf16 v80, s44, v44
    v_dot2c_f32_bf16 v81, s45, v44
    v_dot2c_f32_bf16 v82, s44, v45
    v_dot2c_f32_bf16 v83, s45, v45
    v_dot2c_f32_bf16 v84, s44, v46
    v_dot2c_f32_bf16 v85, s45, v46
    v_dot2c_f32_bf16 v86, s44, v47
    v_dot2c_f32_bf16 v87, s45, v47
    v_cvt_pk_bf16_f32 v40, v80, v81
    v_cvt_pk_bf16_f32 v41, v82, v83
    v_cvt_pk_bf16_f32 v42, v84, v85
    v_cvt_pk_bf16_f32 v43, v86, v87
    ds_write_b128 v14, v[40:43] offset:25600
    s_waitcnt vmcnt(24)
    s_waitcnt lgkmcnt(0)
    s_barrier
    s_mov_b32 s48, 640
    buffer_load_dwordx4 v[32:35], v10, s[36:39], s48 offen
    buffer_load_dwordx4 v[36:39], v12, s[36:39], s48 offen
    buffer_load_dwordx4 v[40:43], v11, s[36:39], s48 offen
    buffer_load_dwordx4 v[44:47], v13, s[36:39], s48 offen
    s_waitcnt vmcnt(24)
    v_dot2_f32_bf16 v80, v48, s46, 0
    v_dot2_f32_bf16 v81, v48, s47, 0
    v_dot2_f32_bf16 v82, v49, s46, 0
    v_dot2_f32_bf16 v83, v49, s47, 0
    v_dot2_f32_bf16 v84, v50, s46, 0
    v_dot2_f32_bf16 v85, v50, s47, 0
    v_dot2_f32_bf16 v86, v51, s46, 0
    v_dot2_f32_bf16 v87, v51, s47, 0
    v_dot2c_f32_bf16 v80, s44, v52
    v_dot2c_f32_bf16 v81, s45, v52
    v_dot2c_f32_bf16 v82, s44, v53
    v_dot2c_f32_bf16 v83, s45, v53
    v_dot2c_f32_bf16 v84, s44, v54
    v_dot2c_f32_bf16 v85, s45, v54
    v_dot2c_f32_bf16 v86, s44, v55
    v_dot2c_f32_bf16 v87, s45, v55
    v_cvt_pk_bf16_f32 v48, v80, v81
    v_cvt_pk_bf16_f32 v49, v82, v83
    v_cvt_pk_bf16_f32 v50, v84, v85
    v_cvt_pk_bf16_f32 v51, v86, v87
    ds_write_b128 v14, v[48:51] offset:49152
    v_dot2_f32_bf16 v80, v56, s46, 0
    v_dot2_f32_bf16 v81, v56, s47, 0
    v_dot2_f32_bf16 v82, v57, s46, 0
    v_dot2_f32_bf16 v83, v57, s47, 0
    v_dot2_f32_bf16 v84, v58, s46, 0
    v_dot2_f32_bf16 v85, v58, s47, 0
    v_dot2_f32_bf16 v86, v59, s46, 0
    v_dot2_f32_bf16 v87, v59, s47, 0
    v_dot2c_f32_bf16 v80, s44, v60
    v_dot2c_f32_bf16 v81, s45, v60
    v_dot2c_f32_bf16 v82, s44, v61
    v_dot2c_f32_bf16 v83, s45, v61
    v_dot2c_f32_bf16 v84, s44, v62
    v_dot2c_f32_bf16 v85, s45, v62
    v_dot2c_f32_bf16 v86, s44, v63
    v_dot2c_f32_bf16 v87, s45, v63
    v_cvt_pk_bf16_f32 v56, v80, v81
    v_cvt_pk_bf16_f32 v57, v82, v83
    v_cvt_pk_bf16_f32 v58, v84, v85
    v_cvt_pk_bf16_f32 v59, v86, v87
    ds_write_b128 v14, v[56:59] offset:50176
    s_waitcnt vmcnt(20)
    s_waitcnt lgkmcnt(0)
    s_barrier
    s_mov_b32 s48, 768
    buffer_load_dwordx4 v[48:51], v10, s[36:39], s48 offen
    buffer_load_dwordx4 v[52:55], v12, s[36:39], s48 offen
    buffer_load_dwordx4 v[56:59], v11, s[36:39], s48 offen
    buffer_load_dwordx4 v[60:63], v13, s[36:39], s48 offen
    s_add_u32 m0, s61, 0
    s_add_u32 s48, s59, 640
    buffer_load_dwordx4 v7, s[40:43], s48 offen lds
    s_add_u32 m0, s61, 1024
    s_add_u32 s48, s59, 8832
    buffer_load_dwordx4 v8, s[40:43], s48 offen lds
    s_add_u32 m0, s61, 2048
    s_add_u32 s48, s59, 17024
    buffer_load_dwordx4 v7, s[40:43], s48 offen lds
    s_add_u32 m0, s61, 3072
    s_add_u32 s48, s59, 25216
    buffer_load_dwordx4 v8, s[40:43], s48 offen lds
    s_waitcnt vmcnt(24)
    v_dot2_f32_bf16 v80, v64, s46, 0
    v_dot2_f32_bf16 v81, v64, s47, 0
    v_dot2_f32_bf16 v82, v65, s46, 0
    v_dot2_f32_bf16 v83, v65, s47, 0
    v_dot2_f32_bf16 v84, v66, s46, 0
    v_dot2_f32_bf16 v85, v66, s47, 0
    v_dot2_f32_bf16 v86, v67, s46, 0
    v_dot2_f32_bf16 v87, v67, s47, 0
    v_dot2c_f32_bf16 v80, s44, v68
    v_dot2c_f32_bf16 v81, s45, v68
    v_dot2c_f32_bf16 v82, s44, v69
    v_dot2c_f32_bf16 v83, s45, v69
    v_dot2c_f32_bf16 v84, s44, v70
    v_dot2c_f32_bf16 v85, s45, v70
    v_dot2c_f32_bf16 v86, s44, v71
    v_dot2c_f32_bf16 v87, s45, v71
    v_cvt_pk_bf16_f32 v64, v80, v81
    v_cvt_pk_bf16_f32 v65, v82, v83
    v_cvt_pk_bf16_f32 v66, v84, v85
    v_cvt_pk_bf16_f32 v67, v86, v87
    v_add_u32 v3, 73728, v14
    ds_write_b128 v3, v[64:67]
    v_dot2_f32_bf16 v80, v72, s46, 0
    v_dot2_f32_bf16 v81, v72, s47, 0
    v_dot2_f32_bf16 v82, v73, s46, 0
    v_dot2_f32_bf16 v83, v73, s47, 0
    v_dot2_f32_bf16 v84, v74, s46, 0
    v_dot2_f32_bf16 v85, v74, s47, 0
    v_dot2_f32_bf16 v86, v75, s46, 0
    v_dot2_f32_bf16 v87, v75, s47, 0
    v_dot2c_f32_bf16 v80, s44, v76
    v_dot2c_f32_bf16 v81, s45, v76
    v_dot2c_f32_bf16 v82, s44, v77
    v_dot2c_f32_bf16 v83, s45, v77
    v_dot2c_f32_bf16 v84, s44, v78
    v_dot2c_f32_bf16 v85, s45, v78
    v_dot2c_f32_bf16 v86, s44, v79
    v_dot2c_f32_bf16 v87, s45, v79
    v_cvt_pk_bf16_f32 v72, v80, v81
    v_cvt_pk_bf16_f32 v73, v82, v83
    v_cvt_pk_bf16_f32 v74, v84, v85
    v_cvt_pk_bf16_f32 v75, v86, v87
    v_add_u32 v3, 74752, v14
    ds_write_b128 v3, v[72:75]
    s_waitcnt vmcnt(20)
    s_waitcnt lgkmcnt(0)
    s_barrier
    s_mov_b32 s48, 896
    buffer_load_dwordx4 v[64:67], v10, s[36:39], s48 offen
    buffer_load_dwordx4 v[68:71], v12, s[36:39], s48 offen
    buffer_load_dwordx4 v[72:75], v11, s[36:39], s48 offen
    buffer_load_dwordx4 v[76:79], v13, s[36:39], s48 offen
    s_add_u32 m0, s61, 24576
    s_add_u32 s48, s59, 768
    buffer_load_dwordx4 v7, s[40:43], s48 offen lds
    s_add_u32 m0, s61, 25600
    s_add_u32 s48, s59, 8960
    buffer_load_dwordx4 v8, s[40:43], s48 offen lds
    s_add_u32 m0, s61, 26624
    s_add_u32 s48, s59, 17152
    buffer_load_dwordx4 v7, s[40:43], s48 offen lds
    s_add_u32 m0, s61, 27648
    s_add_u32 s48, s59, 25344
    buffer_load_dwordx4 v8, s[40:43], s48 offen lds
    s_waitcnt vmcnt(24)
    v_dot2_f32_bf16 v80, v16, s46, 0
    v_dot2_f32_bf16 v81, v16, s47, 0
    v_dot2_f32_bf16 v82, v17, s46, 0
    v_dot2_f32_bf16 v83, v17, s47, 0
    v_dot2_f32_bf16 v84, v18, s46, 0
    v_dot2_f32_bf16 v85, v18, s47, 0
    v_dot2_f32_bf16 v86, v19, s46, 0
    v_dot2_f32_bf16 v87, v19, s47, 0
    v_dot2c_f32_bf16 v80, s44, v20
    v_dot2c_f32_bf16 v81, s45, v20
    v_dot2c_f32_bf16 v82, s44, v21
    v_dot2c_f32_bf16 v83, s45, v21
    v_dot2c_f32_bf16 v84, s44, v22
    v_dot2c_f32_bf16 v85, s45, v22
    v_dot2c_f32_bf16 v86, s44, v23
    v_dot2c_f32_bf16 v87, s45, v23
    v_cvt_pk_bf16_f32 v16, v80, v81
    v_cvt_pk_bf16_f32 v17, v82, v83
    v_cvt_pk_bf16_f32 v18, v84, v85
    v_cvt_pk_bf16_f32 v19, v86, v87
    v_add_u32 v3, 98304, v14
    ds_write_b128 v3, v[16:19]
    v_dot2_f32_bf16 v80, v24, s46, 0
    v_dot2_f32_bf16 v81, v24, s47, 0
    v_dot2_f32_bf16 v82, v25, s46, 0
    v_dot2_f32_bf16 v83, v25, s47, 0
    v_dot2_f32_bf16 v84, v26, s46, 0
    v_dot2_f32_bf16 v85, v26, s47, 0
    v_dot2_f32_bf16 v86, v27, s46, 0
    v_dot2_f32_bf16 v87, v27, s47, 0
    v_dot2c_f32_bf16 v80, s44, v28
    v_dot2c_f32_bf16 v81, s45, v28
    v_dot2c_f32_bf16 v82, s44, v29
    v_dot2c_f32_bf16 v83, s45, v29
    v_dot2c_f32_bf16 v84, s44, v30
    v_dot2c_f32_bf16 v85, s45, v30
    v_dot2c_f32_bf16 v86, s44, v31
    v_dot2c_f32_bf16 v87, s45, v31
    v_cvt_pk_bf16_f32 v24, v80, v81
    v_cvt_pk_bf16_f32 v25, v82, v83
    v_cvt_pk_bf16_f32 v26, v84, v85
    v_cvt_pk_bf16_f32 v27, v86, v87
    v_add_u32 v3, 99328, v14
    ds_write_b128 v3, v[24:27]
    s_waitcnt vmcnt(20)
    s_waitcnt lgkmcnt(0)
    s_barrier
    s_add_u32 m0, s61, 49152
    s_add_u32 s48, s59, 896
    buffer_load_dwordx4 v7, s[40:43], s48 offen lds
    s_add_u32 m0, s61, 50176
    s_add_u32 s48, s59, 9088
    buffer_load_dwordx4 v8, s[40:43], s48 offen lds
    s_add_u32 m0, s61, 51200
    s_add_u32 s48, s59, 17280
    buffer_load_dwordx4 v7, s[40:43], s48 offen lds
    s_add_u32 m0, s61, 52224
    s_add_u32 s48, s59, 25472
    buffer_load_dwordx4 v8, s[40:43], s48 offen lds
    s_waitcnt vmcnt(20)
    v_dot2_f32_bf16 v80, v32, s46, 0
    v_dot2_f32_bf16 v81, v32, s47, 0
    v_dot2_f32_bf16 v82, v33, s46, 0
    v_dot2_f32_bf16 v83, v33, s47, 0
    v_dot2_f32_bf16 v84, v34, s46, 0
    v_dot2_f32_bf16 v85, v34, s47, 0
    v_dot2_f32_bf16 v86, v35, s46, 0
    v_dot2_f32_bf16 v87, v35, s47, 0
    v_dot2c_f32_bf16 v80, s44, v36
    v_dot2c_f32_bf16 v81, s45, v36
    v_dot2c_f32_bf16 v82, s44, v37
    v_dot2c_f32_bf16 v83, s45, v37
    v_dot2c_f32_bf16 v84, s44, v38
    v_dot2c_f32_bf16 v85, s45, v38
    v_dot2c_f32_bf16 v86, s44, v39
    v_dot2c_f32_bf16 v87, s45, v39
    v_cvt_pk_bf16_f32 v32, v80, v81
    v_cvt_pk_bf16_f32 v33, v82, v83
    v_cvt_pk_bf16_f32 v34, v84, v85
    v_cvt_pk_bf16_f32 v35, v86, v87
    ds_write_b128 v14, v[32:35] offset:0
    v_dot2_f32_bf16 v80, v40, s46, 0
    v_dot2_f32_bf16 v81, v40, s47, 0
    v_dot2_f32_bf16 v82, v41, s46, 0
    v_dot2_f32_bf16 v83, v41, s47, 0
    v_dot2_f32_bf16 v84, v42, s46, 0
    v_dot2_f32_bf16 v85, v42, s47, 0
    v_dot2_f32_bf16 v86, v43, s46, 0
    v_dot2_f32_bf16 v87, v43, s47, 0
    v_dot2c_f32_bf16 v80, s44, v44
    v_dot2c_f32_bf16 v81, s45, v44
    v_dot2c_f32_bf16 v82, s44, v45
    v_dot2c_f32_bf16 v83, s45, v45
    v_dot2c_f32_bf16 v84, s44, v46
    v_dot2c_f32_bf16 v85, s45, v46
    v_dot2c_f32_bf16 v86, s44, v47
    v_dot2c_f32_bf16 v87, s45, v47
    v_cvt_pk_bf16_f32 v40, v80, v81
    v_cvt_pk_bf16_f32 v41, v82, v83
    v_cvt_pk_bf16_f32 v42, v84, v85
    v_cvt_pk_bf16_f32 v43, v86, v87
    ds_write_b128 v14, v[40:43] offset:1024
    s_waitcnt vmcnt(12)
    s_waitcnt lgkmcnt(0)
    s_barrier
    v_dot2_f32_bf16 v80, v48, s46, 0
    v_dot2_f32_bf16 v81, v48, s47, 0
    v_dot2_f32_bf16 v82, v49, s46, 0
    v_dot2_f32_bf16 v83, v49, s47, 0
    v_dot2_f32_bf16 v84, v50, s46, 0
    v_dot2_f32_bf16 v85, v50, s47, 0
    v_dot2_f32_bf16 v86, v51, s46, 0
    v_dot2_f32_bf16 v87, v51, s47, 0
    v_dot2c_f32_bf16 v80, s44, v52
    v_dot2c_f32_bf16 v81, s45, v52
    v_dot2c_f32_bf16 v82, s44, v53
    v_dot2c_f32_bf16 v83, s45, v53
    v_dot2c_f32_bf16 v84, s44, v54
    v_dot2c_f32_bf16 v85, s45, v54
    v_dot2c_f32_bf16 v86, s44, v55
    v_dot2c_f32_bf16 v87, s45, v55
    v_cvt_pk_bf16_f32 v48, v80, v81
    v_cvt_pk_bf16_f32 v49, v82, v83
    v_cvt_pk_bf16_f32 v50, v84, v85
    v_cvt_pk_bf16_f32 v51, v86, v87
    ds_write_b128 v14, v[48:51] offset:24576
    v_dot2_f32_bf16 v80, v56, s46, 0
    v_dot2_f32_bf16 v81, v56, s47, 0
    v_dot2_f32_bf16 v82, v57, s46, 0
    v_dot2_f32_bf16 v83, v57, s47, 0
    v_dot2_f32_bf16 v84, v58, s46, 0
    v_dot2_f32_bf16 v85, v58, s47, 0
    v_dot2_f32_bf16 v86, v59, s46, 0
    v_dot2_f32_bf16 v87, v59, s47, 0
    v_dot2c_f32_bf16 v80, s44, v60
    v_dot2c_f32_bf16 v81, s45, v60
    v_dot2c_f32_bf16 v82, s44, v61
    v_dot2c_f32_bf16 v83, s45, v61
    v_dot2c_f32_bf16 v84, s44, v62
    v_dot2c_f32_bf16 v85, s45, v62
    v_dot2c_f32_bf16 v86, s44, v63
    v_dot2c_f32_bf16 v87, s45, v63
    v_cvt_pk_bf16_f32 v56, v80, v81
    v_cvt_pk_bf16_f32 v57, v82, v83
    v_cvt_pk_bf16_f32 v58, v84, v85
    v_cvt_pk_bf16_f32 v59, v86, v87
    ds_write_b128 v14, v[56:59] offset:25600
    s_waitcnt vmcnt(4)
    s_waitcnt lgkmcnt(0)
    s_barrier
    v_dot2_f32_bf16 v80, v64, s46, 0
    v_dot2_f32_bf16 v81, v64, s47, 0
    v_dot2_f32_bf16 v82, v65, s46, 0
    v_dot2_f32_bf16 v83, v65, s47, 0
    v_dot2_f32_bf16 v84, v66, s46, 0
    v_dot2_f32_bf16 v85, v66, s47, 0
    v_dot2_f32_bf16 v86, v67, s46, 0
    v_dot2_f32_bf16 v87, v67, s47, 0
    v_dot2c_f32_bf16 v80, s44, v68
    v_dot2c_f32_bf16 v81, s45, v68
    v_dot2c_f32_bf16 v82, s44, v69
    v_dot2c_f32_bf16 v83, s45, v69
    v_dot2c_f32_bf16 v84, s44, v70
    v_dot2c_f32_bf16 v85, s45, v70
    v_dot2c_f32_bf16 v86, s44, v71
    v_dot2c_f32_bf16 v87, s45, v71
    v_cvt_pk_bf16_f32 v64, v80, v81
    v_cvt_pk_bf16_f32 v65, v82, v83
    v_cvt_pk_bf16_f32 v66, v84, v85
    v_cvt_pk_bf16_f32 v67, v86, v87
    ds_write_b128 v14, v[64:67] offset:49152
    v_dot2_f32_bf16 v80, v72, s46, 0
    v_dot2_f32_bf16 v81, v72, s47, 0
    v_dot2_f32_bf16 v82, v73, s46, 0
    v_dot2_f32_bf16 v83, v73, s47, 0
    v_dot2_f32_bf16 v84, v74, s46, 0
    v_dot2_f32_bf16 v85, v74, s47, 0
    v_dot2_f32_bf16 v86, v75, s46, 0
    v_dot2_f32_bf16 v87, v75, s47, 0
    v_dot2c_f32_bf16 v80, s44, v76
    v_dot2c_f32_bf16 v81, s45, v76
    v_dot2c_f32_bf16 v82, s44, v77
    v_dot2c_f32_bf16 v83, s45, v77
    v_dot2c_f32_bf16 v84, s44, v78
    v_dot2c_f32_bf16 v85, s45, v78
    v_dot2c_f32_bf16 v86, s44, v79
    v_dot2c_f32_bf16 v87, s45, v79
    v_cvt_pk_bf16_f32 v72, v80, v81
    v_cvt_pk_bf16_f32 v73, v82, v83
    v_cvt_pk_bf16_f32 v74, v84, v85
    v_cvt_pk_bf16_f32 v75, v86, v87
    ds_write_b128 v14, v[72:75] offset:50176
    s_waitcnt vmcnt(0)
    s_waitcnt lgkmcnt(0)
    s_barrier
    s_barrier
    s_branch gated_mix__softmax_full_mha__spectral_fnet__prompt_kernel_attn
gated_mix__softmax_full_mha__spectral_fnet__prompt_kernel_cons:
    s_lshr_b32 s56, s28, 1
    s_and_b32 s57, s28, 1
    v_and_b32 v3, 31, v1
    v_lshrrev_b32 v4, 5, v1
    v_lshrrev_b32 v5, 1, v3
    v_and_b32 v5, 7, v5
    v_xor_b32 v5, v5, v4
    v_lshlrev_b32 v5, 4, v5
    v_lshlrev_b32 v3, 7, v3
    v_add_u32 v3, v3, v5
    s_cmp_lg_u32 s30, 0
    s_cbranch_scc1 gated_mix__softmax_full_mha__spectral_fnet__prompt_kernel_cF
    s_lshl_b32 s48, s57, 13
    v_xor_b32 v6, 0, v3
    v_add_u32 v7, s48, v6
    v_add_u32 v11, 65536, v7
    v_xor_b32 v6, 32, v3
    v_add_u32 v8, s48, v6
    v_add_u32 v12, 65536, v8
    v_xor_b32 v6, 64, v3
    v_add_u32 v9, s48, v6
    v_add_u32 v13, 65536, v9
    v_xor_b32 v6, 96, v3
    v_add_u32 v10, s48, v6
    v_add_u32 v14, 65536, v10
    v_bfe_u32 v3, v1, 2, 2
    v_lshrrev_b32 v4, 5, v1
    v_lshlrev_b32 v4, 3, v4
    v_add_u32 v4, v4, v3
    v_lshlrev_b32 v4, 8, v4
    v_bfe_u32 v5, v1, 4, 1
    v_lshlrev_b32 v5, 5, v5
    v_add_u32 v4, v4, v5
    v_and_b32 v5, 3, v1
    v_lshlrev_b32 v5, 3, v5
    v_add_u32 v4, v4, v5
    v_add_u32 v4, 16384, v4
    s_lshl_b32 s48, s56, 1
    s_add_u32 s49, s48, 0
    v_xor_b32 v5, s49, v3
    v_lshlrev_b32 v5, 6, v5
    v_add_u32 v19, v4, v5
    v_add_u32 v21, 65536, v19
    s_add_u32 s49, s48, 1
    v_xor_b32 v5, s49, v3
    v_lshlrev_b32 v5, 6, v5
    v_add_u32 v20, v4, v5
    v_add_u32 v22, 65536, v20
    s_waitcnt lgkmcnt(0)
    v_mov_b32 v84, 0
    v_mov_b32 v85, 0
    v_mov_b32 v86, 0
    v_mov_b32 v87, 0
    v_mov_b32 v88, 0
    v_mov_b32 v89, 0
    v_mov_b32 v90, 0
    v_mov_b32 v91, 0
    v_mov_b32 v92, 0
    v_mov_b32 v93, 0
    v_mov_b32 v94, 0
    v_mov_b32 v95, 0
    v_mov_b32 v96, 0
    v_mov_b32 v97, 0
    v_mov_b32 v98, 0
    v_mov_b32 v99, 0
    v_mov_b32 v100, 0
    v_mov_b32 v101, 0
    v_mov_b32 v102, 0
    v_mov_b32 v103, 0
    v_mov_b32 v104, 0
    v_mov_b32 v105, 0
    v_mov_b32 v106, 0
    v_mov_b32 v107, 0
    v_mov_b32 v108, 0
    v_mov_b32 v109, 0
    v_mov_b32 v110, 0
    v_mov_b32 v111, 0
    v_mov_b32 v112, 0
    v_mov_b32 v113, 0
    v_mov_b32 v114, 0
    v_mov_b32 v115, 0
    v_mov_b32 v116, 0
    v_mov_b32 v117, 0
    v_mov_b32 v118, 0
    v_mov_b32 v119, 0
    v_mov_b32 v120, 0
    v_mov_b32 v121, 0
    v_mov_b32 v122, 0
    v_mov_b32 v123, 0
    v_mov_b32 v124, 0
    v_mov_b32 v125, 0
    v_mov_b32 v126, 0
    v_mov_b32 v127, 0
    v_mov_b32 v128, 0
    v_mov_b32 v129, 0
    v_mov_b32 v130, 0
    v_mov_b32 v131, 0
    v_mov_b32 v132, 0
    v_mov_b32 v133, 0
    v_mov_b32 v134, 0
    v_mov_b32 v135, 0
    v_mov_b32 v136, 0
    v_mov_b32 v137, 0
    v_mov_b32 v138, 0
    v_mov_b32 v139, 0
    v_mov_b32 v140, 0
    v_mov_b32 v141, 0
    v_mov_b32 v142, 0
    v_mov_b32 v143, 0
    v_mov_b32 v144, 0
    v_mov_b32 v145, 0
    v_mov_b32 v146, 0
    v_mov_b32 v147, 0
    s_mov_b32 s32, s26
    s_and_b32 s33, s27, 0xffff
    s_mov_b32 s34, 20971520
    s_mov_b32 s35, 0x00020000
    s_cmp_ge_u32 s54, 8
    s_cbranch_scc1 gated_mix__softmax_full_mha__spectral_fnet__prompt_kernel_vtype
    s_barrier
    ds_read_b128 v[36:39], v7 offset:0
    ds_read_b128 v[40:43], v7 offset:4096
    ds_read_b64_tr_b16 v[60:61], v19 offset:0
    ds_read_b64_tr_b16 v[62:63], v19 offset:1024
    ds_read_b64_tr_b16 v[64:65], v20 offset:0
    ds_read_b64_tr_b16 v[66:67], v20 offset:1024
    ds_read_b128 v[44:47], v8 offset:0
    ds_read_b128 v[48:51], v8 offset:4096
    ds_read_b64_tr_b16 v[68:69], v19 offset:4096
    ds_read_b64_tr_b16 v[70:71], v19 offset:5120
    ds_read_b64_tr_b16 v[72:73], v20 offset:4096
    ds_read_b64_tr_b16 v[74:75], v20 offset:5120
    ds_read_b128 v[52:55], v9 offset:0
    ds_read_b128 v[56:59], v9 offset:4096
    ds_read_b64_tr_b16 v[76:77], v19 offset:8192
    ds_read_b64_tr_b16 v[78:79], v19 offset:9216
    ds_read_b64_tr_b16 v[80:81], v20 offset:8192
    ds_read_b64_tr_b16 v[82:83], v20 offset:9216
    s_waitcnt lgkmcnt(12)
    v_mfma_f32_32x32x16_bf16 v[84:99], v[60:63], v[36:39], v[84:99]
    v_mfma_f32_32x32x16_bf16 v[100:115], v[60:63], v[40:43], v[100:115]
    v_mfma_f32_32x32x16_bf16 v[116:131], v[64:67], v[36:39], v[116:131]
    v_mfma_f32_32x32x16_bf16 v[132:147], v[64:67], v[40:43], v[132:147]
    ds_read_b128 v[36:39], v10 offset:0
    ds_read_b128 v[40:43], v10 offset:4096
    ds_read_b64_tr_b16 v[60:61], v19 offset:12288
    ds_read_b64_tr_b16 v[62:63], v19 offset:13312
    ds_read_b64_tr_b16 v[64:65], v20 offset:12288
    ds_read_b64_tr_b16 v[66:67], v20 offset:13312
    s_waitcnt lgkmcnt(12)
    v_mfma_f32_32x32x16_bf16 v[84:99], v[68:71], v[44:47], v[84:99]
    v_mfma_f32_32x32x16_bf16 v[100:115], v[68:71], v[48:51], v[100:115]
    v_mfma_f32_32x32x16_bf16 v[116:131], v[72:75], v[44:47], v[116:131]
    v_mfma_f32_32x32x16_bf16 v[132:147], v[72:75], v[48:51], v[132:147]
    s_barrier
    ds_read_b128 v[44:47], v7 offset:32768
    ds_read_b128 v[48:51], v7 offset:36864
    ds_read_b64_tr_b16 v[68:69], v19 offset:32768
    ds_read_b64_tr_b16 v[70:71], v19 offset:33792
    ds_read_b64_tr_b16 v[72:73], v20 offset:32768
    ds_read_b64_tr_b16 v[74:75], v20 offset:33792
    s_waitcnt lgkmcnt(12)
    v_mfma_f32_32x32x16_bf16 v[84:99], v[76:79], v[52:55], v[84:99]
    v_mfma_f32_32x32x16_bf16 v[100:115], v[76:79], v[56:59], v[100:115]
    v_mfma_f32_32x32x16_bf16 v[116:131], v[80:83], v[52:55], v[116:131]
    v_mfma_f32_32x32x16_bf16 v[132:147], v[80:83], v[56:59], v[132:147]
    ds_read_b128 v[52:55], v8 offset:32768
    ds_read_b128 v[56:59], v8 offset:36864
    ds_read_b64_tr_b16 v[76:77], v19 offset:36864
    ds_read_b64_tr_b16 v[78:79], v19 offset:37888
    ds_read_b64_tr_b16 v[80:81], v20 offset:36864
    ds_read_b64_tr_b16 v[82:83], v20 offset:37888
    s_waitcnt lgkmcnt(12)
    v_mfma_f32_32x32x16_bf16 v[84:99], v[60:63], v[36:39], v[84:99]
    v_mfma_f32_32x32x16_bf16 v[100:115], v[60:63], v[40:43], v[100:115]
    v_mfma_f32_32x32x16_bf16 v[116:131], v[64:67], v[36:39], v[116:131]
    v_mfma_f32_32x32x16_bf16 v[132:147], v[64:67], v[40:43], v[132:147]
    ds_read_b128 v[36:39], v9 offset:32768
    ds_read_b128 v[40:43], v9 offset:36864
    ds_read_b64_tr_b16 v[60:61], v19 offset:40960
    ds_read_b64_tr_b16 v[62:63], v19 offset:41984
    ds_read_b64_tr_b16 v[64:65], v20 offset:40960
    ds_read_b64_tr_b16 v[66:67], v20 offset:41984
    s_waitcnt lgkmcnt(12)
    v_mfma_f32_32x32x16_bf16 v[84:99], v[68:71], v[44:47], v[84:99]
    v_mfma_f32_32x32x16_bf16 v[100:115], v[68:71], v[48:51], v[100:115]
    v_mfma_f32_32x32x16_bf16 v[116:131], v[72:75], v[44:47], v[116:131]
    v_mfma_f32_32x32x16_bf16 v[132:147], v[72:75], v[48:51], v[132:147]
    ds_read_b128 v[44:47], v10 offset:32768
    ds_read_b128 v[48:51], v10 offset:36864
    ds_read_b64_tr_b16 v[68:69], v19 offset:45056
    ds_read_b64_tr_b16 v[70:71], v19 offset:46080
    ds_read_b64_tr_b16 v[72:73], v20 offset:45056
    ds_read_b64_tr_b16 v[74:75], v20 offset:46080
    s_waitcnt lgkmcnt(12)
    v_mfma_f32_32x32x16_bf16 v[84:99], v[76:79], v[52:55], v[84:99]
    v_mfma_f32_32x32x16_bf16 v[100:115], v[76:79], v[56:59], v[100:115]
    v_mfma_f32_32x32x16_bf16 v[116:131], v[80:83], v[52:55], v[116:131]
    v_mfma_f32_32x32x16_bf16 v[132:147], v[80:83], v[56:59], v[132:147]
    s_barrier
    ds_read_b128 v[52:55], v11 offset:0
    ds_read_b128 v[56:59], v11 offset:4096
    ds_read_b64_tr_b16 v[76:77], v21 offset:0
    ds_read_b64_tr_b16 v[78:79], v21 offset:1024
    ds_read_b64_tr_b16 v[80:81], v22 offset:0
    ds_read_b64_tr_b16 v[82:83], v22 offset:1024
    s_waitcnt lgkmcnt(12)
    v_mfma_f32_32x32x16_bf16 v[84:99], v[60:63], v[36:39], v[84:99]
    v_mfma_f32_32x32x16_bf16 v[100:115], v[60:63], v[40:43], v[100:115]
    v_mfma_f32_32x32x16_bf16 v[116:131], v[64:67], v[36:39], v[116:131]
    v_mfma_f32_32x32x16_bf16 v[132:147], v[64:67], v[40:43], v[132:147]
    ds_read_b128 v[36:39], v12 offset:0
    ds_read_b128 v[40:43], v12 offset:4096
    ds_read_b64_tr_b16 v[60:61], v21 offset:4096
    ds_read_b64_tr_b16 v[62:63], v21 offset:5120
    ds_read_b64_tr_b16 v[64:65], v22 offset:4096
    ds_read_b64_tr_b16 v[66:67], v22 offset:5120
    s_waitcnt lgkmcnt(12)
    v_mfma_f32_32x32x16_bf16 v[84:99], v[68:71], v[44:47], v[84:99]
    v_mfma_f32_32x32x16_bf16 v[100:115], v[68:71], v[48:51], v[100:115]
    v_mfma_f32_32x32x16_bf16 v[116:131], v[72:75], v[44:47], v[116:131]
    v_mfma_f32_32x32x16_bf16 v[132:147], v[72:75], v[48:51], v[132:147]
    ds_read_b128 v[44:47], v13 offset:0
    ds_read_b128 v[48:51], v13 offset:4096
    ds_read_b64_tr_b16 v[68:69], v21 offset:8192
    ds_read_b64_tr_b16 v[70:71], v21 offset:9216
    ds_read_b64_tr_b16 v[72:73], v22 offset:8192
    ds_read_b64_tr_b16 v[74:75], v22 offset:9216
    s_waitcnt lgkmcnt(12)
    v_mfma_f32_32x32x16_bf16 v[84:99], v[76:79], v[52:55], v[84:99]
    v_mfma_f32_32x32x16_bf16 v[100:115], v[76:79], v[56:59], v[100:115]
    v_mfma_f32_32x32x16_bf16 v[116:131], v[80:83], v[52:55], v[116:131]
    v_mfma_f32_32x32x16_bf16 v[132:147], v[80:83], v[56:59], v[132:147]
    ds_read_b128 v[52:55], v14 offset:0
    ds_read_b128 v[56:59], v14 offset:4096
    ds_read_b64_tr_b16 v[76:77], v21 offset:12288
    ds_read_b64_tr_b16 v[78:79], v21 offset:13312
    ds_read_b64_tr_b16 v[80:81], v22 offset:12288
    ds_read_b64_tr_b16 v[82:83], v22 offset:13312
    s_waitcnt lgkmcnt(12)
    v_mfma_f32_32x32x16_bf16 v[84:99], v[60:63], v[36:39], v[84:99]
    v_mfma_f32_32x32x16_bf16 v[100:115], v[60:63], v[40:43], v[100:115]
    v_mfma_f32_32x32x16_bf16 v[116:131], v[64:67], v[36:39], v[116:131]
    v_mfma_f32_32x32x16_bf16 v[132:147], v[64:67], v[40:43], v[132:147]
    s_barrier
    ds_read_b128 v[36:39], v11 offset:32768
    ds_read_b128 v[40:43], v11 offset:36864
    ds_read_b64_tr_b16 v[60:61], v21 offset:32768
    ds_read_b64_tr_b16 v[62:63], v21 offset:33792
    ds_read_b64_tr_b16 v[64:65], v22 offset:32768
    ds_read_b64_tr_b16 v[66:67], v22 offset:33792
    s_waitcnt lgkmcnt(12)
    v_mfma_f32_32x32x16_bf16 v[84:99], v[68:71], v[44:47], v[84:99]
    v_mfma_f32_32x32x16_bf16 v[100:115], v[68:71], v[48:51], v[100:115]
    v_mfma_f32_32x32x16_bf16 v[116:131], v[72:75], v[44:47], v[116:131]
    v_mfma_f32_32x32x16_bf16 v[132:147], v[72:75], v[48:51], v[132:147]
    ds_read_b128 v[44:47], v12 offset:32768
    ds_read_b128 v[48:51], v12 offset:36864
    ds_read_b64_tr_b16 v[68:69], v21 offset:36864
    ds_read_b64_tr_b16 v[70:71], v21 offset:37888
    ds_read_b64_tr_b16 v[72:73], v22 offset:36864
    ds_read_b64_tr_b16 v[74:75], v22 offset:37888
    s_waitcnt lgkmcnt(12)
    v_mfma_f32_32x32x16_bf16 v[84:99], v[76:79], v[52:55], v[84:99]
    v_mfma_f32_32x32x16_bf16 v[100:115], v[76:79], v[56:59], v[100:115]
    v_mfma_f32_32x32x16_bf16 v[116:131], v[80:83], v[52:55], v[116:131]
    v_mfma_f32_32x32x16_bf16 v[132:147], v[80:83], v[56:59], v[132:147]
    ds_read_b128 v[52:55], v13 offset:32768
    ds_read_b128 v[56:59], v13 offset:36864
    ds_read_b64_tr_b16 v[76:77], v21 offset:40960
    ds_read_b64_tr_b16 v[78:79], v21 offset:41984
    ds_read_b64_tr_b16 v[80:81], v22 offset:40960
    ds_read_b64_tr_b16 v[82:83], v22 offset:41984
    s_waitcnt lgkmcnt(12)
    v_mfma_f32_32x32x16_bf16 v[84:99], v[60:63], v[36:39], v[84:99]
    v_mfma_f32_32x32x16_bf16 v[100:115], v[60:63], v[40:43], v[100:115]
    v_mfma_f32_32x32x16_bf16 v[116:131], v[64:67], v[36:39], v[116:131]
    v_mfma_f32_32x32x16_bf16 v[132:147], v[64:67], v[40:43], v[132:147]
    ds_read_b128 v[36:39], v14 offset:32768
    ds_read_b128 v[40:43], v14 offset:36864
    ds_read_b64_tr_b16 v[60:61], v21 offset:45056
    ds_read_b64_tr_b16 v[62:63], v21 offset:46080
    ds_read_b64_tr_b16 v[64:65], v22 offset:45056
    ds_read_b64_tr_b16 v[66:67], v22 offset:46080
    s_waitcnt lgkmcnt(12)
    v_mfma_f32_32x32x16_bf16 v[84:99], v[68:71], v[44:47], v[84:99]
    v_mfma_f32_32x32x16_bf16 v[100:115], v[68:71], v[48:51], v[100:115]
    v_mfma_f32_32x32x16_bf16 v[116:131], v[72:75], v[44:47], v[116:131]
    v_mfma_f32_32x32x16_bf16 v[132:147], v[72:75], v[48:51], v[132:147]
    s_barrier
    ds_read_b128 v[44:47], v7 offset:0
    ds_read_b128 v[48:51], v7 offset:4096
    ds_read_b64_tr_b16 v[68:69], v19 offset:0
    ds_read_b64_tr_b16 v[70:71], v19 offset:1024
    ds_read_b64_tr_b16 v[72:73], v20 offset:0
    ds_read_b64_tr_b16 v[74:75], v20 offset:1024
    s_waitcnt lgkmcnt(12)
    v_mfma_f32_32x32x16_bf16 v[84:99], v[76:79], v[52:55], v[84:99]
    v_mfma_f32_32x32x16_bf16 v[100:115], v[76:79], v[56:59], v[100:115]
    v_mfma_f32_32x32x16_bf16 v[116:131], v[80:83], v[52:55], v[116:131]
    v_mfma_f32_32x32x16_bf16 v[132:147], v[80:83], v[56:59], v[132:147]
    ds_read_b128 v[52:55], v8 offset:0
    ds_read_b128 v[56:59], v8 offset:4096
    ds_read_b64_tr_b16 v[76:77], v19 offset:4096
    ds_read_b64_tr_b16 v[78:79], v19 offset:5120
    ds_read_b64_tr_b16 v[80:81], v20 offset:4096
    ds_read_b64_tr_b16 v[82:83], v20 offset:5120
    s_waitcnt lgkmcnt(12)
    v_mfma_f32_32x32x16_bf16 v[84:99], v[60:63], v[36:39], v[84:99]
    v_mfma_f32_32x32x16_bf16 v[100:115], v[60:63], v[40:43], v[100:115]
    v_mfma_f32_32x32x16_bf16 v[116:131], v[64:67], v[36:39], v[116:131]
    v_mfma_f32_32x32x16_bf16 v[132:147], v[64:67], v[40:43], v[132:147]
    ds_read_b128 v[36:39], v9 offset:0
    ds_read_b128 v[40:43], v9 offset:4096
    ds_read_b64_tr_b16 v[60:61], v19 offset:8192
    ds_read_b64_tr_b16 v[62:63], v19 offset:9216
    ds_read_b64_tr_b16 v[64:65], v20 offset:8192
    ds_read_b64_tr_b16 v[66:67], v20 offset:9216
    s_waitcnt lgkmcnt(12)
    v_mfma_f32_32x32x16_bf16 v[84:99], v[68:71], v[44:47], v[84:99]
    v_mfma_f32_32x32x16_bf16 v[100:115], v[68:71], v[48:51], v[100:115]
    v_mfma_f32_32x32x16_bf16 v[116:131], v[72:75], v[44:47], v[116:131]
    v_mfma_f32_32x32x16_bf16 v[132:147], v[72:75], v[48:51], v[132:147]
    ds_read_b128 v[44:47], v10 offset:0
    ds_read_b128 v[48:51], v10 offset:4096
    ds_read_b64_tr_b16 v[68:69], v19 offset:12288
    ds_read_b64_tr_b16 v[70:71], v19 offset:13312
    ds_read_b64_tr_b16 v[72:73], v20 offset:12288
    ds_read_b64_tr_b16 v[74:75], v20 offset:13312
    s_waitcnt lgkmcnt(12)
    v_mfma_f32_32x32x16_bf16 v[84:99], v[76:79], v[52:55], v[84:99]
    v_mfma_f32_32x32x16_bf16 v[100:115], v[76:79], v[56:59], v[100:115]
    v_mfma_f32_32x32x16_bf16 v[116:131], v[80:83], v[52:55], v[116:131]
    v_mfma_f32_32x32x16_bf16 v[132:147], v[80:83], v[56:59], v[132:147]
    s_barrier
    ds_read_b128 v[52:55], v7 offset:32768
    ds_read_b128 v[56:59], v7 offset:36864
    ds_read_b64_tr_b16 v[76:77], v19 offset:32768
    ds_read_b64_tr_b16 v[78:79], v19 offset:33792
    ds_read_b64_tr_b16 v[80:81], v20 offset:32768
    ds_read_b64_tr_b16 v[82:83], v20 offset:33792
    s_waitcnt lgkmcnt(12)
    v_mfma_f32_32x32x16_bf16 v[84:99], v[60:63], v[36:39], v[84:99]
    v_mfma_f32_32x32x16_bf16 v[100:115], v[60:63], v[40:43], v[100:115]
    v_mfma_f32_32x32x16_bf16 v[116:131], v[64:67], v[36:39], v[116:131]
    v_mfma_f32_32x32x16_bf16 v[132:147], v[64:67], v[40:43], v[132:147]
    ds_read_b128 v[36:39], v8 offset:32768
    ds_read_b128 v[40:43], v8 offset:36864
    ds_read_b64_tr_b16 v[60:61], v19 offset:36864
    ds_read_b64_tr_b16 v[62:63], v19 offset:37888
    ds_read_b64_tr_b16 v[64:65], v20 offset:36864
    ds_read_b64_tr_b16 v[66:67], v20 offset:37888
    s_waitcnt lgkmcnt(12)
    v_mfma_f32_32x32x16_bf16 v[84:99], v[68:71], v[44:47], v[84:99]
    v_mfma_f32_32x32x16_bf16 v[100:115], v[68:71], v[48:51], v[100:115]
    v_mfma_f32_32x32x16_bf16 v[116:131], v[72:75], v[44:47], v[116:131]
    v_mfma_f32_32x32x16_bf16 v[132:147], v[72:75], v[48:51], v[132:147]
    ds_read_b128 v[44:47], v9 offset:32768
    ds_read_b128 v[48:51], v9 offset:36864
    ds_read_b64_tr_b16 v[68:69], v19 offset:40960
    ds_read_b64_tr_b16 v[70:71], v19 offset:41984
    ds_read_b64_tr_b16 v[72:73], v20 offset:40960
    ds_read_b64_tr_b16 v[74:75], v20 offset:41984
    s_waitcnt lgkmcnt(12)
    v_mfma_f32_32x32x16_bf16 v[84:99], v[76:79], v[52:55], v[84:99]
    v_mfma_f32_32x32x16_bf16 v[100:115], v[76:79], v[56:59], v[100:115]
    v_mfma_f32_32x32x16_bf16 v[116:131], v[80:83], v[52:55], v[116:131]
    v_mfma_f32_32x32x16_bf16 v[132:147], v[80:83], v[56:59], v[132:147]
    ds_read_b128 v[52:55], v10 offset:32768
    ds_read_b128 v[56:59], v10 offset:36864
    ds_read_b64_tr_b16 v[76:77], v19 offset:45056
    ds_read_b64_tr_b16 v[78:79], v19 offset:46080
    ds_read_b64_tr_b16 v[80:81], v20 offset:45056
    ds_read_b64_tr_b16 v[82:83], v20 offset:46080
    s_waitcnt lgkmcnt(12)
    v_mfma_f32_32x32x16_bf16 v[84:99], v[60:63], v[36:39], v[84:99]
    v_mfma_f32_32x32x16_bf16 v[100:115], v[60:63], v[40:43], v[100:115]
    v_mfma_f32_32x32x16_bf16 v[116:131], v[64:67], v[36:39], v[116:131]
    v_mfma_f32_32x32x16_bf16 v[132:147], v[64:67], v[40:43], v[132:147]
    s_barrier
    ds_read_b128 v[36:39], v11 offset:0
    ds_read_b128 v[40:43], v11 offset:4096
    ds_read_b64_tr_b16 v[60:61], v21 offset:0
    ds_read_b64_tr_b16 v[62:63], v21 offset:1024
    ds_read_b64_tr_b16 v[64:65], v22 offset:0
    ds_read_b64_tr_b16 v[66:67], v22 offset:1024
    s_waitcnt lgkmcnt(12)
    v_mfma_f32_32x32x16_bf16 v[84:99], v[68:71], v[44:47], v[84:99]
    v_mfma_f32_32x32x16_bf16 v[100:115], v[68:71], v[48:51], v[100:115]
    v_mfma_f32_32x32x16_bf16 v[116:131], v[72:75], v[44:47], v[116:131]
    v_mfma_f32_32x32x16_bf16 v[132:147], v[72:75], v[48:51], v[132:147]
    ds_read_b128 v[44:47], v12 offset:0
    ds_read_b128 v[48:51], v12 offset:4096
    ds_read_b64_tr_b16 v[68:69], v21 offset:4096
    ds_read_b64_tr_b16 v[70:71], v21 offset:5120
    ds_read_b64_tr_b16 v[72:73], v22 offset:4096
    ds_read_b64_tr_b16 v[74:75], v22 offset:5120
    s_waitcnt lgkmcnt(12)
    v_mfma_f32_32x32x16_bf16 v[84:99], v[76:79], v[52:55], v[84:99]
    v_mfma_f32_32x32x16_bf16 v[100:115], v[76:79], v[56:59], v[100:115]
    v_mfma_f32_32x32x16_bf16 v[116:131], v[80:83], v[52:55], v[116:131]
    v_mfma_f32_32x32x16_bf16 v[132:147], v[80:83], v[56:59], v[132:147]
    ds_read_b128 v[52:55], v13 offset:0
    ds_read_b128 v[56:59], v13 offset:4096
    ds_read_b64_tr_b16 v[76:77], v21 offset:8192
    ds_read_b64_tr_b16 v[78:79], v21 offset:9216
    ds_read_b64_tr_b16 v[80:81], v22 offset:8192
    ds_read_b64_tr_b16 v[82:83], v22 offset:9216
    s_waitcnt lgkmcnt(12)
    v_mfma_f32_32x32x16_bf16 v[84:99], v[60:63], v[36:39], v[84:99]
    v_mfma_f32_32x32x16_bf16 v[100:115], v[60:63], v[40:43], v[100:115]
    v_mfma_f32_32x32x16_bf16 v[116:131], v[64:67], v[36:39], v[116:131]
    v_mfma_f32_32x32x16_bf16 v[132:147], v[64:67], v[40:43], v[132:147]
    ds_read_b128 v[36:39], v14 offset:0
    ds_read_b128 v[40:43], v14 offset:4096
    ds_read_b64_tr_b16 v[60:61], v21 offset:12288
    ds_read_b64_tr_b16 v[62:63], v21 offset:13312
    ds_read_b64_tr_b16 v[64:65], v22 offset:12288
    ds_read_b64_tr_b16 v[66:67], v22 offset:13312
    s_waitcnt lgkmcnt(12)
    v_mfma_f32_32x32x16_bf16 v[84:99], v[68:71], v[44:47], v[84:99]
    v_mfma_f32_32x32x16_bf16 v[100:115], v[68:71], v[48:51], v[100:115]
    v_mfma_f32_32x32x16_bf16 v[116:131], v[72:75], v[44:47], v[116:131]
    v_mfma_f32_32x32x16_bf16 v[132:147], v[72:75], v[48:51], v[132:147]
    s_barrier
    ds_read_b128 v[44:47], v11 offset:32768
    ds_read_b128 v[48:51], v11 offset:36864
    ds_read_b64_tr_b16 v[68:69], v21 offset:32768
    ds_read_b64_tr_b16 v[70:71], v21 offset:33792
    ds_read_b64_tr_b16 v[72:73], v22 offset:32768
    ds_read_b64_tr_b16 v[74:75], v22 offset:33792
    s_waitcnt lgkmcnt(12)
    v_mfma_f32_32x32x16_bf16 v[84:99], v[76:79], v[52:55], v[84:99]
    v_mfma_f32_32x32x16_bf16 v[100:115], v[76:79], v[56:59], v[100:115]
    v_mfma_f32_32x32x16_bf16 v[116:131], v[80:83], v[52:55], v[116:131]
    v_mfma_f32_32x32x16_bf16 v[132:147], v[80:83], v[56:59], v[132:147]
    ds_read_b128 v[52:55], v12 offset:32768
    ds_read_b128 v[56:59], v12 offset:36864
    ds_read_b64_tr_b16 v[76:77], v21 offset:36864
    ds_read_b64_tr_b16 v[78:79], v21 offset:37888
    ds_read_b64_tr_b16 v[80:81], v22 offset:36864
    ds_read_b64_tr_b16 v[82:83], v22 offset:37888
    s_waitcnt lgkmcnt(12)
    v_mfma_f32_32x32x16_bf16 v[84:99], v[60:63], v[36:39], v[84:99]
    v_mfma_f32_32x32x16_bf16 v[100:115], v[60:63], v[40:43], v[100:115]
    v_mfma_f32_32x32x16_bf16 v[116:131], v[64:67], v[36:39], v[116:131]
    v_mfma_f32_32x32x16_bf16 v[132:147], v[64:67], v[40:43], v[132:147]
    ds_read_b128 v[36:39], v13 offset:32768
    ds_read_b128 v[40:43], v13 offset:36864
    ds_read_b64_tr_b16 v[60:61], v21 offset:40960
    ds_read_b64_tr_b16 v[62:63], v21 offset:41984
    ds_read_b64_tr_b16 v[64:65], v22 offset:40960
    ds_read_b64_tr_b16 v[66:67], v22 offset:41984
    s_waitcnt lgkmcnt(12)
    v_mfma_f32_32x32x16_bf16 v[84:99], v[68:71], v[44:47], v[84:99]
    v_mfma_f32_32x32x16_bf16 v[100:115], v[68:71], v[48:51], v[100:115]
    v_mfma_f32_32x32x16_bf16 v[116:131], v[72:75], v[44:47], v[116:131]
    v_mfma_f32_32x32x16_bf16 v[132:147], v[72:75], v[48:51], v[132:147]
    ds_read_b128 v[44:47], v14 offset:32768
    ds_read_b128 v[48:51], v14 offset:36864
    ds_read_b64_tr_b16 v[68:69], v21 offset:45056
    ds_read_b64_tr_b16 v[70:71], v21 offset:46080
    ds_read_b64_tr_b16 v[72:73], v22 offset:45056
    ds_read_b64_tr_b16 v[74:75], v22 offset:46080
    s_waitcnt lgkmcnt(12)
    v_mfma_f32_32x32x16_bf16 v[84:99], v[76:79], v[52:55], v[84:99]
    v_mfma_f32_32x32x16_bf16 v[100:115], v[76:79], v[56:59], v[100:115]
    v_mfma_f32_32x32x16_bf16 v[116:131], v[80:83], v[52:55], v[116:131]
    v_mfma_f32_32x32x16_bf16 v[132:147], v[80:83], v[56:59], v[132:147]
    s_waitcnt lgkmcnt(6)
    v_mfma_f32_32x32x16_bf16 v[84:99], v[60:63], v[36:39], v[84:99]
    v_mfma_f32_32x32x16_bf16 v[100:115], v[60:63], v[40:43], v[100:115]
    v_mfma_f32_32x32x16_bf16 v[116:131], v[64:67], v[36:39], v[116:131]
    v_mfma_f32_32x32x16_bf16 v[132:147], v[64:67], v[40:43], v[132:147]
    s_waitcnt lgkmcnt(0)
    v_mfma_f32_32x32x16_bf16 v[84:99], v[68:71], v[44:47], v[84:99]
    v_mfma_f32_32x32x16_bf16 v[100:115], v[68:71], v[48:51], v[100:115]
    v_mfma_f32_32x32x16_bf16 v[116:131], v[72:75], v[44:47], v[116:131]
    v_mfma_f32_32x32x16_bf16 v[132:147], v[72:75], v[48:51], v[132:147]
    s_barrier
    s_cmp_lt_u32 s54, 4
    s_cselect_b32 s50, 1052289595, 1.0
    s_cselect_b32 s48, 0, 2097152
    s_and_b32 s49, s54, 3
    s_lshl_b32 s49, s49, 3
    s_lshl_b32 s51, s56, 2
    s_add_u32 s49, s49, s51
    s_lshl_b32 s49, s49, 16
    s_add_u32 s48, s48, s49
    s_lshr_b32 s49, s52, 5
    s_lshl_b32 s51, s57, 1
    s_add_u32 s49, s49, s51
    s_lshl_b32 s49, s49, 10
    s_add_u32 s48, s48, s49
    s_nop 3
    s_cmp_lt_u32 s54, 4
    s_cbranch_scc0 gated_mix__softmax_full_mha__spectral_fnet__prompt_kernel_noscale
    v_mul_f32 v84, s50, v84
    v_mul_f32 v85, s50, v85
    v_mul_f32 v86, s50, v86
    v_mul_f32 v87, s50, v87
    v_mul_f32 v88, s50, v88
    v_mul_f32 v89, s50, v89
    v_mul_f32 v90, s50, v90
    v_mul_f32 v91, s50, v91
    v_mul_f32 v92, s50, v92
    v_mul_f32 v93, s50, v93
    v_mul_f32 v94, s50, v94
    v_mul_f32 v95, s50, v95
    v_mul_f32 v96, s50, v96
    v_mul_f32 v97, s50, v97
    v_mul_f32 v98, s50, v98
    v_mul_f32 v99, s50, v99
    v_mul_f32 v100, s50, v100
    v_mul_f32 v101, s50, v101
    v_mul_f32 v102, s50, v102
    v_mul_f32 v103, s50, v103
    v_mul_f32 v104, s50, v104
    v_mul_f32 v105, s50, v105
    v_mul_f32 v106, s50, v106
    v_mul_f32 v107, s50, v107
    v_mul_f32 v108, s50, v108
    v_mul_f32 v109, s50, v109
    v_mul_f32 v110, s50, v110
    v_mul_f32 v111, s50, v111
    v_mul_f32 v112, s50, v112
    v_mul_f32 v113, s50, v113
    v_mul_f32 v114, s50, v114
    v_mul_f32 v115, s50, v115
    v_mul_f32 v116, s50, v116
    v_mul_f32 v117, s50, v117
    v_mul_f32 v118, s50, v118
    v_mul_f32 v119, s50, v119
    v_mul_f32 v120, s50, v120
    v_mul_f32 v121, s50, v121
    v_mul_f32 v122, s50, v122
    v_mul_f32 v123, s50, v123
    v_mul_f32 v124, s50, v124
    v_mul_f32 v125, s50, v125
    v_mul_f32 v126, s50, v126
    v_mul_f32 v127, s50, v127
    v_mul_f32 v128, s50, v128
    v_mul_f32 v129, s50, v129
    v_mul_f32 v130, s50, v130
    v_mul_f32 v131, s50, v131
    v_mul_f32 v132, s50, v132
    v_mul_f32 v133, s50, v133
    v_mul_f32 v134, s50, v134
    v_mul_f32 v135, s50, v135
    v_mul_f32 v136, s50, v136
    v_mul_f32 v137, s50, v137
    v_mul_f32 v138, s50, v138
    v_mul_f32 v139, s50, v139
    v_mul_f32 v140, s50, v140
    v_mul_f32 v141, s50, v141
    v_mul_f32 v142, s50, v142
    v_mul_f32 v143, s50, v143
    v_mul_f32 v144, s50, v144
    v_mul_f32 v145, s50, v145
    v_mul_f32 v146, s50, v146
    v_mul_f32 v147, s50, v147
gated_mix__softmax_full_mha__spectral_fnet__prompt_kernel_noscale:
    v_cvt_pk_bf16_f32 v36, v84, v85
    v_cvt_pk_bf16_f32 v37, v86, v87
    v_cvt_pk_bf16_f32 v38, v88, v89
    v_cvt_pk_bf16_f32 v39, v90, v91
    v_cvt_pk_bf16_f32 v40, v92, v93
    v_cvt_pk_bf16_f32 v41, v94, v95
    v_cvt_pk_bf16_f32 v42, v96, v97
    v_cvt_pk_bf16_f32 v43, v98, v99
    s_add_u32 s49, s48, 0
    buffer_store_dwordx4 v[36:39], v2, s[32:35], s49 offen sc1
    s_add_u32 s49, s48, 65536
    buffer_store_dwordx4 v[40:43], v2, s[32:35], s49 offen sc1
    v_cvt_pk_bf16_f32 v44, v100, v101
    v_cvt_pk_bf16_f32 v45, v102, v103
    v_cvt_pk_bf16_f32 v46, v104, v105
    v_cvt_pk_bf16_f32 v47, v106, v107
    v_cvt_pk_bf16_f32 v48, v108, v109
    v_cvt_pk_bf16_f32 v49, v110, v111
    v_cvt_pk_bf16_f32 v50, v112, v113
    v_cvt_pk_bf16_f32 v51, v114, v115
    s_add_u32 s49, s48, 1024
    buffer_store_dwordx4 v[44:47], v2, s[32:35], s49 offen sc1
    s_add_u32 s49, s48, 66560
    buffer_store_dwordx4 v[48:51], v2, s[32:35], s49 offen sc1
    v_cvt_pk_bf16_f32 v52, v116, v117
    v_cvt_pk_bf16_f32 v53, v118, v119
    v_cvt_pk_bf16_f32 v54, v120, v121
    v_cvt_pk_bf16_f32 v55, v122, v123
    v_cvt_pk_bf16_f32 v56, v124, v125
    v_cvt_pk_bf16_f32 v57, v126, v127
    v_cvt_pk_bf16_f32 v58, v128, v129
    v_cvt_pk_bf16_f32 v59, v130, v131
    s_add_u32 s49, s48, 131072
    buffer_store_dwordx4 v[52:55], v2, s[32:35], s49 offen sc1
    s_add_u32 s49, s48, 196608
    buffer_store_dwordx4 v[56:59], v2, s[32:35], s49 offen sc1
    v_cvt_pk_bf16_f32 v36, v132, v133
    v_cvt_pk_bf16_f32 v37, v134, v135
    v_cvt_pk_bf16_f32 v38, v136, v137
    v_cvt_pk_bf16_f32 v39, v138, v139
    v_cvt_pk_bf16_f32 v40, v140, v141
    v_cvt_pk_bf16_f32 v41, v142, v143
    v_cvt_pk_bf16_f32 v42, v144, v145
    v_cvt_pk_bf16_f32 v43, v146, v147
    s_add_u32 s49, s48, 132096
    buffer_store_dwordx4 v[36:39], v2, s[32:35], s49 offen sc1
    s_add_u32 s49, s48, 197632
    buffer_store_dwordx4 v[40:43], v2, s[32:35], s49 offen sc1
    v_mov_b32 v3, 135168
    ds_read_b32 v4, v3
    s_waitcnt lgkmcnt(0)
    v_readfirstlane_b32 s29, v4
    s_nop 3
    s_waitcnt vmcnt(0)
    v_mov_b32 v3, 135252
    v_mov_b32 v4, 1
    s_mov_b64 exec, 1
    ds_add_rtn_u32 v5, v3, v4
    s_waitcnt lgkmcnt(0)
    s_mov_b64 exec, -1
    v_readfirstlane_b32 s48, v5
    s_nop 3
    s_cmp_lg_u32 s48, 3
    s_cbranch_scc1 gated_mix__softmax_full_mha__spectral_fnet__prompt_kernel_attn
    s_lshl_b32 s51, s62, 5
    s_add_u32 s51, s51, 14745600
    v_mov_b32 v3, s51
    v_mov_b32 v4, s29
    s_mov_b64 exec, 1
    global_store_dword v3, v4, s[26:27] sc1
    s_mov_b64 exec, -1
    s_branch gated_mix__softmax_full_mha__spectral_fnet__prompt_kernel_attn
gated_mix__softmax_full_mha__spectral_fnet__prompt_kernel_vtype:
    s_barrier
    ds_read_b128 v[36:39], v7 offset:0
    ds_read_b128 v[40:43], v7 offset:4096
    ds_read_b64_tr_b16 v[60:61], v19 offset:0
    ds_read_b64_tr_b16 v[62:63], v19 offset:1024
    ds_read_b64_tr_b16 v[64:65], v20 offset:0
    ds_read_b64_tr_b16 v[66:67], v20 offset:1024
    ds_read_b128 v[44:47], v8 offset:0
    ds_read_b128 v[48:51], v8 offset:4096
    ds_read_b64_tr_b16 v[68:69], v19 offset:4096
    ds_read_b64_tr_b16 v[70:71], v19 offset:5120
    ds_read_b64_tr_b16 v[72:73], v20 offset:4096
    ds_read_b64_tr_b16 v[74:75], v20 offset:5120
    ds_read_b128 v[52:55], v9 offset:0
    ds_read_b128 v[56:59], v9 offset:4096
    ds_read_b64_tr_b16 v[76:77], v19 offset:8192
    ds_read_b64_tr_b16 v[78:79], v19 offset:9216
    ds_read_b64_tr_b16 v[80:81], v20 offset:8192
    ds_read_b64_tr_b16 v[82:83], v20 offset:9216
    s_waitcnt lgkmcnt(12)
    v_mfma_f32_32x32x16_bf16 v[84:99], v[36:39], v[60:63], v[84:99]
    v_mfma_f32_32x32x16_bf16 v[100:115], v[40:43], v[60:63], v[100:115]
    v_mfma_f32_32x32x16_bf16 v[116:131], v[36:39], v[64:67], v[116:131]
    v_mfma_f32_32x32x16_bf16 v[132:147], v[40:43], v[64:67], v[132:147]
    ds_read_b128 v[36:39], v10 offset:0
    ds_read_b128 v[40:43], v10 offset:4096
    ds_read_b64_tr_b16 v[60:61], v19 offset:12288
    ds_read_b64_tr_b16 v[62:63], v19 offset:13312
    ds_read_b64_tr_b16 v[64:65], v20 offset:12288
    ds_read_b64_tr_b16 v[66:67], v20 offset:13312
    s_waitcnt lgkmcnt(12)
    v_mfma_f32_32x32x16_bf16 v[84:99], v[44:47], v[68:71], v[84:99]
    v_mfma_f32_32x32x16_bf16 v[100:115], v[48:51], v[68:71], v[100:115]
    v_mfma_f32_32x32x16_bf16 v[116:131], v[44:47], v[72:75], v[116:131]
    v_mfma_f32_32x32x16_bf16 v[132:147], v[48:51], v[72:75], v[132:147]
    s_barrier
    ds_read_b128 v[44:47], v7 offset:32768
    ds_read_b128 v[48:51], v7 offset:36864
    ds_read_b64_tr_b16 v[68:69], v19 offset:32768
    ds_read_b64_tr_b16 v[70:71], v19 offset:33792
    ds_read_b64_tr_b16 v[72:73], v20 offset:32768
    ds_read_b64_tr_b16 v[74:75], v20 offset:33792
    s_waitcnt lgkmcnt(12)
    v_mfma_f32_32x32x16_bf16 v[84:99], v[52:55], v[76:79], v[84:99]
    v_mfma_f32_32x32x16_bf16 v[100:115], v[56:59], v[76:79], v[100:115]
    v_mfma_f32_32x32x16_bf16 v[116:131], v[52:55], v[80:83], v[116:131]
    v_mfma_f32_32x32x16_bf16 v[132:147], v[56:59], v[80:83], v[132:147]
    ds_read_b128 v[52:55], v8 offset:32768
    ds_read_b128 v[56:59], v8 offset:36864
    ds_read_b64_tr_b16 v[76:77], v19 offset:36864
    ds_read_b64_tr_b16 v[78:79], v19 offset:37888
    ds_read_b64_tr_b16 v[80:81], v20 offset:36864
    ds_read_b64_tr_b16 v[82:83], v20 offset:37888
    s_waitcnt lgkmcnt(12)
    v_mfma_f32_32x32x16_bf16 v[84:99], v[36:39], v[60:63], v[84:99]
    v_mfma_f32_32x32x16_bf16 v[100:115], v[40:43], v[60:63], v[100:115]
    v_mfma_f32_32x32x16_bf16 v[116:131], v[36:39], v[64:67], v[116:131]
    v_mfma_f32_32x32x16_bf16 v[132:147], v[40:43], v[64:67], v[132:147]
    ds_read_b128 v[36:39], v9 offset:32768
    ds_read_b128 v[40:43], v9 offset:36864
    ds_read_b64_tr_b16 v[60:61], v19 offset:40960
    ds_read_b64_tr_b16 v[62:63], v19 offset:41984
    ds_read_b64_tr_b16 v[64:65], v20 offset:40960
    ds_read_b64_tr_b16 v[66:67], v20 offset:41984
    s_waitcnt lgkmcnt(12)
    v_mfma_f32_32x32x16_bf16 v[84:99], v[44:47], v[68:71], v[84:99]
    v_mfma_f32_32x32x16_bf16 v[100:115], v[48:51], v[68:71], v[100:115]
    v_mfma_f32_32x32x16_bf16 v[116:131], v[44:47], v[72:75], v[116:131]
    v_mfma_f32_32x32x16_bf16 v[132:147], v[48:51], v[72:75], v[132:147]
    ds_read_b128 v[44:47], v10 offset:32768
    ds_read_b128 v[48:51], v10 offset:36864
    ds_read_b64_tr_b16 v[68:69], v19 offset:45056
    ds_read_b64_tr_b16 v[70:71], v19 offset:46080
    ds_read_b64_tr_b16 v[72:73], v20 offset:45056
    ds_read_b64_tr_b16 v[74:75], v20 offset:46080
    s_waitcnt lgkmcnt(12)
    v_mfma_f32_32x32x16_bf16 v[84:99], v[52:55], v[76:79], v[84:99]
    v_mfma_f32_32x32x16_bf16 v[100:115], v[56:59], v[76:79], v[100:115]
    v_mfma_f32_32x32x16_bf16 v[116:131], v[52:55], v[80:83], v[116:131]
    v_mfma_f32_32x32x16_bf16 v[132:147], v[56:59], v[80:83], v[132:147]
    s_barrier
    ds_read_b128 v[52:55], v11 offset:0
    ds_read_b128 v[56:59], v11 offset:4096
    ds_read_b64_tr_b16 v[76:77], v21 offset:0
    ds_read_b64_tr_b16 v[78:79], v21 offset:1024
    ds_read_b64_tr_b16 v[80:81], v22 offset:0
    ds_read_b64_tr_b16 v[82:83], v22 offset:1024
    s_waitcnt lgkmcnt(12)
    v_mfma_f32_32x32x16_bf16 v[84:99], v[36:39], v[60:63], v[84:99]
    v_mfma_f32_32x32x16_bf16 v[100:115], v[40:43], v[60:63], v[100:115]
    v_mfma_f32_32x32x16_bf16 v[116:131], v[36:39], v[64:67], v[116:131]
    v_mfma_f32_32x32x16_bf16 v[132:147], v[40:43], v[64:67], v[132:147]
    ds_read_b128 v[36:39], v12 offset:0
    ds_read_b128 v[40:43], v12 offset:4096
    ds_read_b64_tr_b16 v[60:61], v21 offset:4096
    ds_read_b64_tr_b16 v[62:63], v21 offset:5120
    ds_read_b64_tr_b16 v[64:65], v22 offset:4096
    ds_read_b64_tr_b16 v[66:67], v22 offset:5120
    s_waitcnt lgkmcnt(12)
    v_mfma_f32_32x32x16_bf16 v[84:99], v[44:47], v[68:71], v[84:99]
    v_mfma_f32_32x32x16_bf16 v[100:115], v[48:51], v[68:71], v[100:115]
    v_mfma_f32_32x32x16_bf16 v[116:131], v[44:47], v[72:75], v[116:131]
    v_mfma_f32_32x32x16_bf16 v[132:147], v[48:51], v[72:75], v[132:147]
    ds_read_b128 v[44:47], v13 offset:0
    ds_read_b128 v[48:51], v13 offset:4096
    ds_read_b64_tr_b16 v[68:69], v21 offset:8192
    ds_read_b64_tr_b16 v[70:71], v21 offset:9216
    ds_read_b64_tr_b16 v[72:73], v22 offset:8192
    ds_read_b64_tr_b16 v[74:75], v22 offset:9216
    s_waitcnt lgkmcnt(12)
    v_mfma_f32_32x32x16_bf16 v[84:99], v[52:55], v[76:79], v[84:99]
    v_mfma_f32_32x32x16_bf16 v[100:115], v[56:59], v[76:79], v[100:115]
    v_mfma_f32_32x32x16_bf16 v[116:131], v[52:55], v[80:83], v[116:131]
    v_mfma_f32_32x32x16_bf16 v[132:147], v[56:59], v[80:83], v[132:147]
    ds_read_b128 v[52:55], v14 offset:0
    ds_read_b128 v[56:59], v14 offset:4096
    ds_read_b64_tr_b16 v[76:77], v21 offset:12288
    ds_read_b64_tr_b16 v[78:79], v21 offset:13312
    ds_read_b64_tr_b16 v[80:81], v22 offset:12288
    ds_read_b64_tr_b16 v[82:83], v22 offset:13312
    s_waitcnt lgkmcnt(12)
    v_mfma_f32_32x32x16_bf16 v[84:99], v[36:39], v[60:63], v[84:99]
    v_mfma_f32_32x32x16_bf16 v[100:115], v[40:43], v[60:63], v[100:115]
    v_mfma_f32_32x32x16_bf16 v[116:131], v[36:39], v[64:67], v[116:131]
    v_mfma_f32_32x32x16_bf16 v[132:147], v[40:43], v[64:67], v[132:147]
    s_barrier
    ds_read_b128 v[36:39], v11 offset:32768
    ds_read_b128 v[40:43], v11 offset:36864
    ds_read_b64_tr_b16 v[60:61], v21 offset:32768
    ds_read_b64_tr_b16 v[62:63], v21 offset:33792
    ds_read_b64_tr_b16 v[64:65], v22 offset:32768
    ds_read_b64_tr_b16 v[66:67], v22 offset:33792
    s_waitcnt lgkmcnt(12)
    v_mfma_f32_32x32x16_bf16 v[84:99], v[44:47], v[68:71], v[84:99]
    v_mfma_f32_32x32x16_bf16 v[100:115], v[48:51], v[68:71], v[100:115]
    v_mfma_f32_32x32x16_bf16 v[116:131], v[44:47], v[72:75], v[116:131]
    v_mfma_f32_32x32x16_bf16 v[132:147], v[48:51], v[72:75], v[132:147]
    ds_read_b128 v[44:47], v12 offset:32768
    ds_read_b128 v[48:51], v12 offset:36864
    ds_read_b64_tr_b16 v[68:69], v21 offset:36864
    ds_read_b64_tr_b16 v[70:71], v21 offset:37888
    ds_read_b64_tr_b16 v[72:73], v22 offset:36864
    ds_read_b64_tr_b16 v[74:75], v22 offset:37888
    s_waitcnt lgkmcnt(12)
    v_mfma_f32_32x32x16_bf16 v[84:99], v[52:55], v[76:79], v[84:99]
    v_mfma_f32_32x32x16_bf16 v[100:115], v[56:59], v[76:79], v[100:115]
    v_mfma_f32_32x32x16_bf16 v[116:131], v[52:55], v[80:83], v[116:131]
    v_mfma_f32_32x32x16_bf16 v[132:147], v[56:59], v[80:83], v[132:147]
    ds_read_b128 v[52:55], v13 offset:32768
    ds_read_b128 v[56:59], v13 offset:36864
    ds_read_b64_tr_b16 v[76:77], v21 offset:40960
    ds_read_b64_tr_b16 v[78:79], v21 offset:41984
    ds_read_b64_tr_b16 v[80:81], v22 offset:40960
    ds_read_b64_tr_b16 v[82:83], v22 offset:41984
    s_waitcnt lgkmcnt(12)
    v_mfma_f32_32x32x16_bf16 v[84:99], v[36:39], v[60:63], v[84:99]
    v_mfma_f32_32x32x16_bf16 v[100:115], v[40:43], v[60:63], v[100:115]
    v_mfma_f32_32x32x16_bf16 v[116:131], v[36:39], v[64:67], v[116:131]
    v_mfma_f32_32x32x16_bf16 v[132:147], v[40:43], v[64:67], v[132:147]
    ds_read_b128 v[36:39], v14 offset:32768
    ds_read_b128 v[40:43], v14 offset:36864
    ds_read_b64_tr_b16 v[60:61], v21 offset:45056
    ds_read_b64_tr_b16 v[62:63], v21 offset:46080
    ds_read_b64_tr_b16 v[64:65], v22 offset:45056
    ds_read_b64_tr_b16 v[66:67], v22 offset:46080
    s_waitcnt lgkmcnt(12)
    v_mfma_f32_32x32x16_bf16 v[84:99], v[44:47], v[68:71], v[84:99]
    v_mfma_f32_32x32x16_bf16 v[100:115], v[48:51], v[68:71], v[100:115]
    v_mfma_f32_32x32x16_bf16 v[116:131], v[44:47], v[72:75], v[116:131]
    v_mfma_f32_32x32x16_bf16 v[132:147], v[48:51], v[72:75], v[132:147]
    s_barrier
    ds_read_b128 v[44:47], v7 offset:0
    ds_read_b128 v[48:51], v7 offset:4096
    ds_read_b64_tr_b16 v[68:69], v19 offset:0
    ds_read_b64_tr_b16 v[70:71], v19 offset:1024
    ds_read_b64_tr_b16 v[72:73], v20 offset:0
    ds_read_b64_tr_b16 v[74:75], v20 offset:1024
    s_waitcnt lgkmcnt(12)
    v_mfma_f32_32x32x16_bf16 v[84:99], v[52:55], v[76:79], v[84:99]
    v_mfma_f32_32x32x16_bf16 v[100:115], v[56:59], v[76:79], v[100:115]
    v_mfma_f32_32x32x16_bf16 v[116:131], v[52:55], v[80:83], v[116:131]
    v_mfma_f32_32x32x16_bf16 v[132:147], v[56:59], v[80:83], v[132:147]
    ds_read_b128 v[52:55], v8 offset:0
    ds_read_b128 v[56:59], v8 offset:4096
    ds_read_b64_tr_b16 v[76:77], v19 offset:4096
    ds_read_b64_tr_b16 v[78:79], v19 offset:5120
    ds_read_b64_tr_b16 v[80:81], v20 offset:4096
    ds_read_b64_tr_b16 v[82:83], v20 offset:5120
    s_waitcnt lgkmcnt(12)
    v_mfma_f32_32x32x16_bf16 v[84:99], v[36:39], v[60:63], v[84:99]
    v_mfma_f32_32x32x16_bf16 v[100:115], v[40:43], v[60:63], v[100:115]
    v_mfma_f32_32x32x16_bf16 v[116:131], v[36:39], v[64:67], v[116:131]
    v_mfma_f32_32x32x16_bf16 v[132:147], v[40:43], v[64:67], v[132:147]
    ds_read_b128 v[36:39], v9 offset:0
    ds_read_b128 v[40:43], v9 offset:4096
    ds_read_b64_tr_b16 v[60:61], v19 offset:8192
    ds_read_b64_tr_b16 v[62:63], v19 offset:9216
    ds_read_b64_tr_b16 v[64:65], v20 offset:8192
    ds_read_b64_tr_b16 v[66:67], v20 offset:9216
    s_waitcnt lgkmcnt(12)
    v_mfma_f32_32x32x16_bf16 v[84:99], v[44:47], v[68:71], v[84:99]
    v_mfma_f32_32x32x16_bf16 v[100:115], v[48:51], v[68:71], v[100:115]
    v_mfma_f32_32x32x16_bf16 v[116:131], v[44:47], v[72:75], v[116:131]
    v_mfma_f32_32x32x16_bf16 v[132:147], v[48:51], v[72:75], v[132:147]
    ds_read_b128 v[44:47], v10 offset:0
    ds_read_b128 v[48:51], v10 offset:4096
    ds_read_b64_tr_b16 v[68:69], v19 offset:12288
    ds_read_b64_tr_b16 v[70:71], v19 offset:13312
    ds_read_b64_tr_b16 v[72:73], v20 offset:12288
    ds_read_b64_tr_b16 v[74:75], v20 offset:13312
    s_waitcnt lgkmcnt(12)
    v_mfma_f32_32x32x16_bf16 v[84:99], v[52:55], v[76:79], v[84:99]
    v_mfma_f32_32x32x16_bf16 v[100:115], v[56:59], v[76:79], v[100:115]
    v_mfma_f32_32x32x16_bf16 v[116:131], v[52:55], v[80:83], v[116:131]
    v_mfma_f32_32x32x16_bf16 v[132:147], v[56:59], v[80:83], v[132:147]
    s_barrier
    ds_read_b128 v[52:55], v7 offset:32768
    ds_read_b128 v[56:59], v7 offset:36864
    ds_read_b64_tr_b16 v[76:77], v19 offset:32768
    ds_read_b64_tr_b16 v[78:79], v19 offset:33792
    ds_read_b64_tr_b16 v[80:81], v20 offset:32768
    ds_read_b64_tr_b16 v[82:83], v20 offset:33792
    s_waitcnt lgkmcnt(12)
    v_mfma_f32_32x32x16_bf16 v[84:99], v[36:39], v[60:63], v[84:99]
    v_mfma_f32_32x32x16_bf16 v[100:115], v[40:43], v[60:63], v[100:115]
    v_mfma_f32_32x32x16_bf16 v[116:131], v[36:39], v[64:67], v[116:131]
    v_mfma_f32_32x32x16_bf16 v[132:147], v[40:43], v[64:67], v[132:147]
    ds_read_b128 v[36:39], v8 offset:32768
    ds_read_b128 v[40:43], v8 offset:36864
    ds_read_b64_tr_b16 v[60:61], v19 offset:36864
    ds_read_b64_tr_b16 v[62:63], v19 offset:37888
    ds_read_b64_tr_b16 v[64:65], v20 offset:36864
    ds_read_b64_tr_b16 v[66:67], v20 offset:37888
    s_waitcnt lgkmcnt(12)
    v_mfma_f32_32x32x16_bf16 v[84:99], v[44:47], v[68:71], v[84:99]
    v_mfma_f32_32x32x16_bf16 v[100:115], v[48:51], v[68:71], v[100:115]
    v_mfma_f32_32x32x16_bf16 v[116:131], v[44:47], v[72:75], v[116:131]
    v_mfma_f32_32x32x16_bf16 v[132:147], v[48:51], v[72:75], v[132:147]
    ds_read_b128 v[44:47], v9 offset:32768
    ds_read_b128 v[48:51], v9 offset:36864
    ds_read_b64_tr_b16 v[68:69], v19 offset:40960
    ds_read_b64_tr_b16 v[70:71], v19 offset:41984
    ds_read_b64_tr_b16 v[72:73], v20 offset:40960
    ds_read_b64_tr_b16 v[74:75], v20 offset:41984
    s_waitcnt lgkmcnt(12)
    v_mfma_f32_32x32x16_bf16 v[84:99], v[52:55], v[76:79], v[84:99]
    v_mfma_f32_32x32x16_bf16 v[100:115], v[56:59], v[76:79], v[100:115]
    v_mfma_f32_32x32x16_bf16 v[116:131], v[52:55], v[80:83], v[116:131]
    v_mfma_f32_32x32x16_bf16 v[132:147], v[56:59], v[80:83], v[132:147]
    ds_read_b128 v[52:55], v10 offset:32768
    ds_read_b128 v[56:59], v10 offset:36864
    ds_read_b64_tr_b16 v[76:77], v19 offset:45056
    ds_read_b64_tr_b16 v[78:79], v19 offset:46080
    ds_read_b64_tr_b16 v[80:81], v20 offset:45056
    ds_read_b64_tr_b16 v[82:83], v20 offset:46080
    s_waitcnt lgkmcnt(12)
    v_mfma_f32_32x32x16_bf16 v[84:99], v[36:39], v[60:63], v[84:99]
    v_mfma_f32_32x32x16_bf16 v[100:115], v[40:43], v[60:63], v[100:115]
    v_mfma_f32_32x32x16_bf16 v[116:131], v[36:39], v[64:67], v[116:131]
    v_mfma_f32_32x32x16_bf16 v[132:147], v[40:43], v[64:67], v[132:147]
    s_barrier
    ds_read_b128 v[36:39], v11 offset:0
    ds_read_b128 v[40:43], v11 offset:4096
    ds_read_b64_tr_b16 v[60:61], v21 offset:0
    ds_read_b64_tr_b16 v[62:63], v21 offset:1024
    ds_read_b64_tr_b16 v[64:65], v22 offset:0
    ds_read_b64_tr_b16 v[66:67], v22 offset:1024
    s_waitcnt lgkmcnt(12)
    v_mfma_f32_32x32x16_bf16 v[84:99], v[44:47], v[68:71], v[84:99]
    v_mfma_f32_32x32x16_bf16 v[100:115], v[48:51], v[68:71], v[100:115]
    v_mfma_f32_32x32x16_bf16 v[116:131], v[44:47], v[72:75], v[116:131]
    v_mfma_f32_32x32x16_bf16 v[132:147], v[48:51], v[72:75], v[132:147]
    ds_read_b128 v[44:47], v12 offset:0
    ds_read_b128 v[48:51], v12 offset:4096
    ds_read_b64_tr_b16 v[68:69], v21 offset:4096
    ds_read_b64_tr_b16 v[70:71], v21 offset:5120
    ds_read_b64_tr_b16 v[72:73], v22 offset:4096
    ds_read_b64_tr_b16 v[74:75], v22 offset:5120
    s_waitcnt lgkmcnt(12)
    v_mfma_f32_32x32x16_bf16 v[84:99], v[52:55], v[76:79], v[84:99]
    v_mfma_f32_32x32x16_bf16 v[100:115], v[56:59], v[76:79], v[100:115]
    v_mfma_f32_32x32x16_bf16 v[116:131], v[52:55], v[80:83], v[116:131]
    v_mfma_f32_32x32x16_bf16 v[132:147], v[56:59], v[80:83], v[132:147]
    ds_read_b128 v[52:55], v13 offset:0
    ds_read_b128 v[56:59], v13 offset:4096
    ds_read_b64_tr_b16 v[76:77], v21 offset:8192
    ds_read_b64_tr_b16 v[78:79], v21 offset:9216
    ds_read_b64_tr_b16 v[80:81], v22 offset:8192
    ds_read_b64_tr_b16 v[82:83], v22 offset:9216
    s_waitcnt lgkmcnt(12)
    v_mfma_f32_32x32x16_bf16 v[84:99], v[36:39], v[60:63], v[84:99]
    v_mfma_f32_32x32x16_bf16 v[100:115], v[40:43], v[60:63], v[100:115]
    v_mfma_f32_32x32x16_bf16 v[116:131], v[36:39], v[64:67], v[116:131]
    v_mfma_f32_32x32x16_bf16 v[132:147], v[40:43], v[64:67], v[132:147]
    ds_read_b128 v[36:39], v14 offset:0
    ds_read_b128 v[40:43], v14 offset:4096
    ds_read_b64_tr_b16 v[60:61], v21 offset:12288
    ds_read_b64_tr_b16 v[62:63], v21 offset:13312
    ds_read_b64_tr_b16 v[64:65], v22 offset:12288
    ds_read_b64_tr_b16 v[66:67], v22 offset:13312
    s_waitcnt lgkmcnt(12)
    v_mfma_f32_32x32x16_bf16 v[84:99], v[44:47], v[68:71], v[84:99]
    v_mfma_f32_32x32x16_bf16 v[100:115], v[48:51], v[68:71], v[100:115]
    v_mfma_f32_32x32x16_bf16 v[116:131], v[44:47], v[72:75], v[116:131]
    v_mfma_f32_32x32x16_bf16 v[132:147], v[48:51], v[72:75], v[132:147]
    s_barrier
    ds_read_b128 v[44:47], v11 offset:32768
    ds_read_b128 v[48:51], v11 offset:36864
    ds_read_b64_tr_b16 v[68:69], v21 offset:32768
    ds_read_b64_tr_b16 v[70:71], v21 offset:33792
    ds_read_b64_tr_b16 v[72:73], v22 offset:32768
    ds_read_b64_tr_b16 v[74:75], v22 offset:33792
    s_waitcnt lgkmcnt(12)
    v_mfma_f32_32x32x16_bf16 v[84:99], v[52:55], v[76:79], v[84:99]
    v_mfma_f32_32x32x16_bf16 v[100:115], v[56:59], v[76:79], v[100:115]
    v_mfma_f32_32x32x16_bf16 v[116:131], v[52:55], v[80:83], v[116:131]
    v_mfma_f32_32x32x16_bf16 v[132:147], v[56:59], v[80:83], v[132:147]
    ds_read_b128 v[52:55], v12 offset:32768
    ds_read_b128 v[56:59], v12 offset:36864
    ds_read_b64_tr_b16 v[76:77], v21 offset:36864
    ds_read_b64_tr_b16 v[78:79], v21 offset:37888
    ds_read_b64_tr_b16 v[80:81], v22 offset:36864
    ds_read_b64_tr_b16 v[82:83], v22 offset:37888
    s_waitcnt lgkmcnt(12)
    v_mfma_f32_32x32x16_bf16 v[84:99], v[36:39], v[60:63], v[84:99]
    v_mfma_f32_32x32x16_bf16 v[100:115], v[40:43], v[60:63], v[100:115]
    v_mfma_f32_32x32x16_bf16 v[116:131], v[36:39], v[64:67], v[116:131]
    v_mfma_f32_32x32x16_bf16 v[132:147], v[40:43], v[64:67], v[132:147]
    ds_read_b128 v[36:39], v13 offset:32768
    ds_read_b128 v[40:43], v13 offset:36864
    ds_read_b64_tr_b16 v[60:61], v21 offset:40960
    ds_read_b64_tr_b16 v[62:63], v21 offset:41984
    ds_read_b64_tr_b16 v[64:65], v22 offset:40960
    ds_read_b64_tr_b16 v[66:67], v22 offset:41984
    s_waitcnt lgkmcnt(12)
    v_mfma_f32_32x32x16_bf16 v[84:99], v[44:47], v[68:71], v[84:99]
    v_mfma_f32_32x32x16_bf16 v[100:115], v[48:51], v[68:71], v[100:115]
    v_mfma_f32_32x32x16_bf16 v[116:131], v[44:47], v[72:75], v[116:131]
    v_mfma_f32_32x32x16_bf16 v[132:147], v[48:51], v[72:75], v[132:147]
    ds_read_b128 v[44:47], v14 offset:32768
    ds_read_b128 v[48:51], v14 offset:36864
    ds_read_b64_tr_b16 v[68:69], v21 offset:45056
    ds_read_b64_tr_b16 v[70:71], v21 offset:46080
    ds_read_b64_tr_b16 v[72:73], v22 offset:45056
    ds_read_b64_tr_b16 v[74:75], v22 offset:46080
    s_waitcnt lgkmcnt(12)
    v_mfma_f32_32x32x16_bf16 v[84:99], v[52:55], v[76:79], v[84:99]
    v_mfma_f32_32x32x16_bf16 v[100:115], v[56:59], v[76:79], v[100:115]
    v_mfma_f32_32x32x16_bf16 v[116:131], v[52:55], v[80:83], v[116:131]
    v_mfma_f32_32x32x16_bf16 v[132:147], v[56:59], v[80:83], v[132:147]
    s_waitcnt lgkmcnt(6)
    v_mfma_f32_32x32x16_bf16 v[84:99], v[36:39], v[60:63], v[84:99]
    v_mfma_f32_32x32x16_bf16 v[100:115], v[40:43], v[60:63], v[100:115]
    v_mfma_f32_32x32x16_bf16 v[116:131], v[36:39], v[64:67], v[116:131]
    v_mfma_f32_32x32x16_bf16 v[132:147], v[40:43], v[64:67], v[132:147]
    s_waitcnt lgkmcnt(0)
    v_mfma_f32_32x32x16_bf16 v[84:99], v[44:47], v[68:71], v[84:99]
    v_mfma_f32_32x32x16_bf16 v[100:115], v[48:51], v[68:71], v[100:115]
    v_mfma_f32_32x32x16_bf16 v[116:131], v[44:47], v[72:75], v[116:131]
    v_mfma_f32_32x32x16_bf16 v[132:147], v[48:51], v[72:75], v[132:147]
    s_barrier
    s_sub_u32 s49, s54, 8
    s_lshl_b32 s49, s49, 3
    s_lshl_b32 s51, s56, 2
    s_add_u32 s49, s49, s51
    s_lshl_b32 s49, s49, 16
    s_add_u32 s48, s49, 4194304
    s_lshr_b32 s49, s52, 4
    s_lshl_b32 s51, s57, 2
    s_add_u32 s49, s49, s51
    s_lshl_b32 s49, s49, 9
    s_add_u32 s48, s48, s49
    v_bfe_u32 v3, v1, 4, 1
    v_lshlrev_b32 v3, 16, v3
    v_lshrrev_b32 v4, 5, v1
    v_lshlrev_b32 v4, 8, v4
    v_add_u32 v3, v3, v4
    v_and_b32 v4, 15, v1
    v_lshlrev_b32 v4, 4, v4
    v_add_u32 v3, v3, v4
    v_cvt_pk_bf16_f32 v36, v84, v85
    v_cvt_pk_bf16_f32 v37, v86, v87
    v_cvt_pk_bf16_f32 v38, v88, v89
    v_cvt_pk_bf16_f32 v39, v90, v91
    v_cvt_pk_bf16_f32 v40, v92, v93
    v_cvt_pk_bf16_f32 v41, v94, v95
    v_cvt_pk_bf16_f32 v42, v96, v97
    v_cvt_pk_bf16_f32 v43, v98, v99
    s_add_u32 s49, s48, 0
    buffer_store_dwordx4 v[36:39], v3, s[32:35], s49 offen sc1
    s_add_u32 s49, s48, 512
    buffer_store_dwordx4 v[40:43], v3, s[32:35], s49 offen sc1
    v_cvt_pk_bf16_f32 v44, v100, v101
    v_cvt_pk_bf16_f32 v45, v102, v103
    v_cvt_pk_bf16_f32 v46, v104, v105
    v_cvt_pk_bf16_f32 v47, v106, v107
    v_cvt_pk_bf16_f32 v48, v108, v109
    v_cvt_pk_bf16_f32 v49, v110, v111
    v_cvt_pk_bf16_f32 v50, v112, v113
    v_cvt_pk_bf16_f32 v51, v114, v115
    s_add_u32 s49, s48, 1024
    buffer_store_dwordx4 v[44:47], v3, s[32:35], s49 offen sc1
    s_add_u32 s49, s48, 1536
    buffer_store_dwordx4 v[48:51], v3, s[32:35], s49 offen sc1
    v_cvt_pk_bf16_f32 v52, v116, v117
    v_cvt_pk_bf16_f32 v53, v118, v119
    v_cvt_pk_bf16_f32 v54, v120, v121
    v_cvt_pk_bf16_f32 v55, v122, v123
    v_cvt_pk_bf16_f32 v56, v124, v125
    v_cvt_pk_bf16_f32 v57, v126, v127
    v_cvt_pk_bf16_f32 v58, v128, v129
    v_cvt_pk_bf16_f32 v59, v130, v131
    s_add_u32 s49, s48, 131072
    buffer_store_dwordx4 v[52:55], v3, s[32:35], s49 offen sc1
    s_add_u32 s49, s48, 131584
    buffer_store_dwordx4 v[56:59], v3, s[32:35], s49 offen sc1
    v_cvt_pk_bf16_f32 v36, v132, v133
    v_cvt_pk_bf16_f32 v37, v134, v135
    v_cvt_pk_bf16_f32 v38, v136, v137
    v_cvt_pk_bf16_f32 v39, v138, v139
    v_cvt_pk_bf16_f32 v40, v140, v141
    v_cvt_pk_bf16_f32 v41, v142, v143
    v_cvt_pk_bf16_f32 v42, v144, v145
    v_cvt_pk_bf16_f32 v43, v146, v147
    s_add_u32 s49, s48, 132096
    buffer_store_dwordx4 v[36:39], v3, s[32:35], s49 offen sc1
    s_add_u32 s49, s48, 132608
    buffer_store_dwordx4 v[40:43], v3, s[32:35], s49 offen sc1
    v_mov_b32 v3, 135168
    ds_read_b32 v4, v3
    s_waitcnt lgkmcnt(0)
    v_readfirstlane_b32 s29, v4
    s_nop 3
    s_waitcnt vmcnt(0)
    v_mov_b32 v3, 135252
    v_mov_b32 v4, 1
    s_mov_b64 exec, 1
    ds_add_rtn_u32 v5, v3, v4
    s_waitcnt lgkmcnt(0)
    s_mov_b64 exec, -1
    v_readfirstlane_b32 s48, v5
    s_nop 3
    s_cmp_lg_u32 s48, 3
    s_cbranch_scc1 gated_mix__softmax_full_mha__spectral_fnet__prompt_kernel_attn
    s_lshl_b32 s51, s62, 5
    s_add_u32 s51, s51, 14745600
    v_mov_b32 v3, s51
    v_mov_b32 v4, s29
    s_mov_b64 exec, 1
    global_store_dword v3, v4, s[26:27] sc1
    s_mov_b64 exec, -1
    s_branch gated_mix__softmax_full_mha__spectral_fnet__prompt_kernel_attn
gated_mix__softmax_full_mha__spectral_fnet__prompt_kernel_cF:
    s_lshl_b32 s48, s57, 12
    s_lshl_b32 s49, s56, 13
    s_add_u32 s49, s49, 8192
    v_xor_b32 v6, 0, v3
    v_add_u32 v7, s48, v6
    v_add_u32 v11, 49152, v7
    v_add_u32 v15, 98304, v7
    v_add_u32 v23, s49, v6
    v_add_u32 v27, 49152, v23
    v_add_u32 v31, 98304, v23
    v_xor_b32 v6, 32, v3
    v_add_u32 v8, s48, v6
    v_add_u32 v12, 49152, v8
    v_add_u32 v16, 98304, v8
    v_add_u32 v24, s49, v6
    v_add_u32 v28, 49152, v24
    v_add_u32 v32, 98304, v24
    v_xor_b32 v6, 64, v3
    v_add_u32 v9, s48, v6
    v_add_u32 v13, 49152, v9
    v_add_u32 v17, 98304, v9
    v_add_u32 v25, s49, v6
    v_add_u32 v29, 49152, v25
    v_add_u32 v33, 98304, v25
    v_xor_b32 v6, 96, v3
    v_add_u32 v10, s48, v6
    v_add_u32 v14, 49152, v10
    v_add_u32 v18, 98304, v10
    v_add_u32 v26, s49, v6
    v_add_u32 v30, 49152, v26
    v_add_u32 v34, 98304, v26
    v_mov_b32 v84, 0
    v_mov_b32 v85, 0
    v_mov_b32 v86, 0
    v_mov_b32 v87, 0
    v_mov_b32 v88, 0
    v_mov_b32 v89, 0
    v_mov_b32 v90, 0
    v_mov_b32 v91, 0
    v_mov_b32 v92, 0
    v_mov_b32 v93, 0
    v_mov_b32 v94, 0
    v_mov_b32 v95, 0
    v_mov_b32 v96, 0
    v_mov_b32 v97, 0
    v_mov_b32 v98, 0
    v_mov_b32 v99, 0
    v_mov_b32 v116, 0
    v_mov_b32 v117, 0
    v_mov_b32 v118, 0
    v_mov_b32 v119, 0
    v_mov_b32 v120, 0
    v_mov_b32 v121, 0
    v_mov_b32 v122, 0
    v_mov_b32 v123, 0
    v_mov_b32 v124, 0
    v_mov_b32 v125, 0
    v_mov_b32 v126, 0
    v_mov_b32 v127, 0
    v_mov_b32 v128, 0
    v_mov_b32 v129, 0
    v_mov_b32 v130, 0
    v_mov_b32 v131, 0
    s_waitcnt lgkmcnt(0)
    s_mov_b32 s32, s26
    s_and_b32 s33, s27, 0xffff
    s_mov_b32 s34, 20971520
    s_mov_b32 s35, 0x00020000
    s_barrier
    ds_read_b128 v[36:39], v7 offset:0
    ds_read_b128 v[60:63], v23 offset:0
    ds_read_b128 v[64:67], v23 offset:4096
    ds_read_b128 v[44:47], v8 offset:0
    ds_read_b128 v[68:71], v24 offset:0
    ds_read_b128 v[72:75], v24 offset:4096
    ds_read_b128 v[52:55], v9 offset:0
    ds_read_b128 v[76:79], v25 offset:0
    ds_read_b128 v[80:83], v25 offset:4096
    s_waitcnt lgkmcnt(6)
    v_mfma_f32_32x32x16_bf16 v[84:99], v[36:39], v[60:63], v[84:99]
    v_mfma_f32_32x32x16_bf16 v[116:131], v[36:39], v[64:67], v[116:131]
    ds_read_b128 v[36:39], v10 offset:0
    ds_read_b128 v[60:63], v26 offset:0
    ds_read_b128 v[64:67], v26 offset:4096
    s_waitcnt lgkmcnt(6)
    v_mfma_f32_32x32x16_bf16 v[84:99], v[44:47], v[68:71], v[84:99]
    v_mfma_f32_32x32x16_bf16 v[116:131], v[44:47], v[72:75], v[116:131]
    s_barrier
    ds_read_b128 v[44:47], v7 offset:24576
    ds_read_b128 v[68:71], v23 offset:24576
    ds_read_b128 v[72:75], v23 offset:28672
    s_waitcnt lgkmcnt(6)
    v_mfma_f32_32x32x16_bf16 v[84:99], v[52:55], v[76:79], v[84:99]
    v_mfma_f32_32x32x16_bf16 v[116:131], v[52:55], v[80:83], v[116:131]
    ds_read_b128 v[52:55], v8 offset:24576
    ds_read_b128 v[76:79], v24 offset:24576
    ds_read_b128 v[80:83], v24 offset:28672
    s_waitcnt lgkmcnt(6)
    v_mfma_f32_32x32x16_bf16 v[84:99], v[36:39], v[60:63], v[84:99]
    v_mfma_f32_32x32x16_bf16 v[116:131], v[36:39], v[64:67], v[116:131]
    ds_read_b128 v[36:39], v9 offset:24576
    ds_read_b128 v[60:63], v25 offset:24576
    ds_read_b128 v[64:67], v25 offset:28672
    s_waitcnt lgkmcnt(6)
    v_mfma_f32_32x32x16_bf16 v[84:99], v[44:47], v[68:71], v[84:99]
    v_mfma_f32_32x32x16_bf16 v[116:131], v[44:47], v[72:75], v[116:131]
    ds_read_b128 v[44:47], v10 offset:24576
    ds_read_b128 v[68:71], v26 offset:24576
    ds_read_b128 v[72:75], v26 offset:28672
    s_waitcnt lgkmcnt(6)
    v_mfma_f32_32x32x16_bf16 v[84:99], v[52:55], v[76:79], v[84:99]
    v_mfma_f32_32x32x16_bf16 v[116:131], v[52:55], v[80:83], v[116:131]
    s_barrier
    ds_read_b128 v[52:55], v11 offset:0
    ds_read_b128 v[76:79], v27 offset:0
    ds_read_b128 v[80:83], v27 offset:4096
    s_waitcnt lgkmcnt(6)
    v_mfma_f32_32x32x16_bf16 v[84:99], v[36:39], v[60:63], v[84:99]
    v_mfma_f32_32x32x16_bf16 v[116:131], v[36:39], v[64:67], v[116:131]
    ds_read_b128 v[36:39], v12 offset:0
    ds_read_b128 v[60:63], v28 offset:0
    ds_read_b128 v[64:67], v28 offset:4096
    s_waitcnt lgkmcnt(6)
    v_mfma_f32_32x32x16_bf16 v[84:99], v[44:47], v[68:71], v[84:99]
    v_mfma_f32_32x32x16_bf16 v[116:131], v[44:47], v[72:75], v[116:131]
    ds_read_b128 v[44:47], v13 offset:0
    ds_read_b128 v[68:71], v29 offset:0
    ds_read_b128 v[72:75], v29 offset:4096
    s_waitcnt lgkmcnt(6)
    v_mfma_f32_32x32x16_bf16 v[84:99], v[52:55], v[76:79], v[84:99]
    v_mfma_f32_32x32x16_bf16 v[116:131], v[52:55], v[80:83], v[116:131]
    ds_read_b128 v[52:55], v14 offset:0
    ds_read_b128 v[76:79], v30 offset:0
    ds_read_b128 v[80:83], v30 offset:4096
    s_waitcnt lgkmcnt(6)
    v_mfma_f32_32x32x16_bf16 v[84:99], v[36:39], v[60:63], v[84:99]
    v_mfma_f32_32x32x16_bf16 v[116:131], v[36:39], v[64:67], v[116:131]
    s_barrier
    ds_read_b128 v[36:39], v11 offset:24576
    ds_read_b128 v[60:63], v27 offset:24576
    ds_read_b128 v[64:67], v27 offset:28672
    s_waitcnt lgkmcnt(6)
    v_mfma_f32_32x32x16_bf16 v[84:99], v[44:47], v[68:71], v[84:99]
    v_mfma_f32_32x32x16_bf16 v[116:131], v[44:47], v[72:75], v[116:131]
    ds_read_b128 v[44:47], v12 offset:24576
    ds_read_b128 v[68:71], v28 offset:24576
    ds_read_b128 v[72:75], v28 offset:28672
    s_waitcnt lgkmcnt(6)
    v_mfma_f32_32x32x16_bf16 v[84:99], v[52:55], v[76:79], v[84:99]
    v_mfma_f32_32x32x16_bf16 v[116:131], v[52:55], v[80:83], v[116:131]
    ds_read_b128 v[52:55], v13 offset:24576
    ds_read_b128 v[76:79], v29 offset:24576
    ds_read_b128 v[80:83], v29 offset:28672
    s_waitcnt lgkmcnt(6)
    v_mfma_f32_32x32x16_bf16 v[84:99], v[36:39], v[60:63], v[84:99]
    v_mfma_f32_32x32x16_bf16 v[116:131], v[36:39], v[64:67], v[116:131]
    ds_read_b128 v[36:39], v14 offset:24576
    ds_read_b128 v[60:63], v30 offset:24576
    ds_read_b128 v[64:67], v30 offset:28672
    s_waitcnt lgkmcnt(6)
    v_mfma_f32_32x32x16_bf16 v[84:99], v[44:47], v[68:71], v[84:99]
    v_mfma_f32_32x32x16_bf16 v[116:131], v[44:47], v[72:75], v[116:131]
    s_barrier
    ds_read_b128 v[44:47], v15 offset:0
    ds_read_b128 v[68:71], v31 offset:0
    ds_read_b128 v[72:75], v31 offset:4096
    s_waitcnt lgkmcnt(6)
    v_mfma_f32_32x32x16_bf16 v[84:99], v[52:55], v[76:79], v[84:99]
    v_mfma_f32_32x32x16_bf16 v[116:131], v[52:55], v[80:83], v[116:131]
    ds_read_b128 v[52:55], v16 offset:0
    ds_read_b128 v[76:79], v32 offset:0
    ds_read_b128 v[80:83], v32 offset:4096
    s_waitcnt lgkmcnt(6)
    v_mfma_f32_32x32x16_bf16 v[84:99], v[36:39], v[60:63], v[84:99]
    v_mfma_f32_32x32x16_bf16 v[116:131], v[36:39], v[64:67], v[116:131]
    ds_read_b128 v[36:39], v17 offset:0
    ds_read_b128 v[60:63], v33 offset:0
    ds_read_b128 v[64:67], v33 offset:4096
    s_waitcnt lgkmcnt(6)
    v_mfma_f32_32x32x16_bf16 v[84:99], v[44:47], v[68:71], v[84:99]
    v_mfma_f32_32x32x16_bf16 v[116:131], v[44:47], v[72:75], v[116:131]
    ds_read_b128 v[44:47], v18 offset:0
    ds_read_b128 v[68:71], v34 offset:0
    ds_read_b128 v[72:75], v34 offset:4096
    s_waitcnt lgkmcnt(6)
    v_mfma_f32_32x32x16_bf16 v[84:99], v[52:55], v[76:79], v[84:99]
    v_mfma_f32_32x32x16_bf16 v[116:131], v[52:55], v[80:83], v[116:131]
    s_barrier
    ds_read_b128 v[52:55], v7 offset:0
    ds_read_b128 v[76:79], v23 offset:0
    ds_read_b128 v[80:83], v23 offset:4096
    s_waitcnt lgkmcnt(6)
    v_mfma_f32_32x32x16_bf16 v[84:99], v[36:39], v[60:63], v[84:99]
    v_mfma_f32_32x32x16_bf16 v[116:131], v[36:39], v[64:67], v[116:131]
    ds_read_b128 v[36:39], v8 offset:0
    ds_read_b128 v[60:63], v24 offset:0
    ds_read_b128 v[64:67], v24 offset:4096
    s_waitcnt lgkmcnt(6)
    v_mfma_f32_32x32x16_bf16 v[84:99], v[44:47], v[68:71], v[84:99]
    v_mfma_f32_32x32x16_bf16 v[116:131], v[44:47], v[72:75], v[116:131]
    ds_read_b128 v[44:47], v9 offset:0
    ds_read_b128 v[68:71], v25 offset:0
    ds_read_b128 v[72:75], v25 offset:4096
    s_waitcnt lgkmcnt(6)
    v_mfma_f32_32x32x16_bf16 v[84:99], v[52:55], v[76:79], v[84:99]
    v_mfma_f32_32x32x16_bf16 v[116:131], v[52:55], v[80:83], v[116:131]
    ds_read_b128 v[52:55], v10 offset:0
    ds_read_b128 v[76:79], v26 offset:0
    ds_read_b128 v[80:83], v26 offset:4096
    s_waitcnt lgkmcnt(6)
    v_mfma_f32_32x32x16_bf16 v[84:99], v[36:39], v[60:63], v[84:99]
    v_mfma_f32_32x32x16_bf16 v[116:131], v[36:39], v[64:67], v[116:131]
    s_barrier
    ds_read_b128 v[36:39], v7 offset:24576
    ds_read_b128 v[60:63], v23 offset:24576
    ds_read_b128 v[64:67], v23 offset:28672
    s_waitcnt lgkmcnt(6)
    v_mfma_f32_32x32x16_bf16 v[84:99], v[44:47], v[68:71], v[84:99]
    v_mfma_f32_32x32x16_bf16 v[116:131], v[44:47], v[72:75], v[116:131]
    ds_read_b128 v[44:47], v8 offset:24576
    ds_read_b128 v[68:71], v24 offset:24576
    ds_read_b128 v[72:75], v24 offset:28672
    s_waitcnt lgkmcnt(6)
    v_mfma_f32_32x32x16_bf16 v[84:99], v[52:55], v[76:79], v[84:99]
    v_mfma_f32_32x32x16_bf16 v[116:131], v[52:55], v[80:83], v[116:131]
    ds_read_b128 v[52:55], v9 offset:24576
    ds_read_b128 v[76:79], v25 offset:24576
    ds_read_b128 v[80:83], v25 offset:28672
    s_waitcnt lgkmcnt(6)
    v_mfma_f32_32x32x16_bf16 v[84:99], v[36:39], v[60:63], v[84:99]
    v_mfma_f32_32x32x16_bf16 v[116:131], v[36:39], v[64:67], v[116:131]
    ds_read_b128 v[36:39], v10 offset:24576
    ds_read_b128 v[60:63], v26 offset:24576
    ds_read_b128 v[64:67], v26 offset:28672
    s_waitcnt lgkmcnt(6)
    v_mfma_f32_32x32x16_bf16 v[84:99], v[44:47], v[68:71], v[84:99]
    v_mfma_f32_32x32x16_bf16 v[116:131], v[44:47], v[72:75], v[116:131]
    s_barrier
    ds_read_b128 v[44:47], v11 offset:0
    ds_read_b128 v[68:71], v27 offset:0
    ds_read_b128 v[72:75], v27 offset:4096
    s_waitcnt lgkmcnt(6)
    v_mfma_f32_32x32x16_bf16 v[84:99], v[52:55], v[76:79], v[84:99]
    v_mfma_f32_32x32x16_bf16 v[116:131], v[52:55], v[80:83], v[116:131]
    ds_read_b128 v[52:55], v12 offset:0
    ds_read_b128 v[76:79], v28 offset:0
    ds_read_b128 v[80:83], v28 offset:4096
    s_waitcnt lgkmcnt(6)
    v_mfma_f32_32x32x16_bf16 v[84:99], v[36:39], v[60:63], v[84:99]
    v_mfma_f32_32x32x16_bf16 v[116:131], v[36:39], v[64:67], v[116:131]
    ds_read_b128 v[36:39], v13 offset:0
    ds_read_b128 v[60:63], v29 offset:0
    ds_read_b128 v[64:67], v29 offset:4096
    s_waitcnt lgkmcnt(6)
    v_mfma_f32_32x32x16_bf16 v[84:99], v[44:47], v[68:71], v[84:99]
    v_mfma_f32_32x32x16_bf16 v[116:131], v[44:47], v[72:75], v[116:131]
    ds_read_b128 v[44:47], v14 offset:0
    ds_read_b128 v[68:71], v30 offset:0
    ds_read_b128 v[72:75], v30 offset:4096
    s_waitcnt lgkmcnt(6)
    v_mfma_f32_32x32x16_bf16 v[84:99], v[52:55], v[76:79], v[84:99]
    v_mfma_f32_32x32x16_bf16 v[116:131], v[52:55], v[80:83], v[116:131]
    s_waitcnt lgkmcnt(3)
    v_mfma_f32_32x32x16_bf16 v[84:99], v[36:39], v[60:63], v[84:99]
    v_mfma_f32_32x32x16_bf16 v[116:131], v[36:39], v[64:67], v[116:131]
    s_waitcnt lgkmcnt(0)
    v_mfma_f32_32x32x16_bf16 v[84:99], v[44:47], v[68:71], v[84:99]
    v_mfma_f32_32x32x16_bf16 v[116:131], v[44:47], v[72:75], v[116:131]
    s_barrier
    s_cmp_eq_u32 s55, 0
    s_mov_b32 s51, 9437184
    s_cselect_b32 s48, 8388608, s51
    s_cselect_b32 s50, 72, 64
    s_lshl_b32 s49, s54, 2
    s_lshl_b32 s51, s56, 1
    s_add_u32 s49, s49, s51
    s_mul_i32 s49, s49, s50
    s_lshr_b32 s51, s52, 4
    s_add_u32 s49, s49, s51
    s_lshl_b32 s51, s57, 1
    s_add_u32 s49, s49, s51
    s_lshl_b32 s49, s49, 10
    s_add_u32 s48, s48, s49
    s_lshl_b32 s50, s50, 10
    s_nop 7
    v_cvt_pk_bf16_f32 v36, v84, v85
    v_cvt_pk_bf16_f32 v37, v86, v87
    v_cvt_pk_bf16_f32 v38, v88, v89
    v_cvt_pk_bf16_f32 v39, v90, v91
    v_cvt_pk_bf16_f32 v40, v92, v93
    v_cvt_pk_bf16_f32 v41, v94, v95
    v_cvt_pk_bf16_f32 v42, v96, v97
    v_cvt_pk_bf16_f32 v43, v98, v99
    s_nop 1
    v_permlane32_swap_b32 v36, v38
    v_permlane32_swap_b32 v37, v39
    v_permlane32_swap_b32 v40, v42
    v_permlane32_swap_b32 v41, v43
    s_add_u32 s49, s48, 0
    buffer_store_dwordx4 v[36:39], v2, s[32:35], s49 offen sc1
    s_add_u32 s49, s48, 1024
    buffer_store_dwordx4 v[40:43], v2, s[32:35], s49 offen sc1
    v_cvt_pk_bf16_f32 v44, v116, v117
    v_cvt_pk_bf16_f32 v45, v118, v119
    v_cvt_pk_bf16_f32 v46, v120, v121
    v_cvt_pk_bf16_f32 v47, v122, v123
    v_cvt_pk_bf16_f32 v48, v124, v125
    v_cvt_pk_bf16_f32 v49, v126, v127
    v_cvt_pk_bf16_f32 v50, v128, v129
    v_cvt_pk_bf16_f32 v51, v130, v131
    s_nop 1
    v_permlane32_swap_b32 v44, v46
    v_permlane32_swap_b32 v45, v47
    v_permlane32_swap_b32 v48, v50
    v_permlane32_swap_b32 v49, v51
    s_add_u32 s48, s48, s50
    s_add_u32 s49, s48, 0
    buffer_store_dwordx4 v[44:47], v2, s[32:35], s49 offen sc1
    s_add_u32 s49, s48, 1024
    buffer_store_dwordx4 v[48:51], v2, s[32:35], s49 offen sc1
    v_mov_b32 v3, 135168
    ds_read_b32 v4, v3
    s_waitcnt lgkmcnt(0)
    v_readfirstlane_b32 s29, v4
    s_nop 3
    s_waitcnt vmcnt(0)
    v_mov_b32 v3, 135252
    v_mov_b32 v4, 1
    s_mov_b64 exec, 1
    ds_add_rtn_u32 v5, v3, v4
    s_waitcnt lgkmcnt(0)
    s_mov_b64 exec, -1
    v_readfirstlane_b32 s48, v5
    s_nop 3
    s_cmp_lg_u32 s48, 3
    s_cbranch_scc1 gated_mix__softmax_full_mha__spectral_fnet__prompt_kernel_attn
    s_lshl_b32 s51, s62, 5
    s_add_u32 s51, s51, 14745600
    v_mov_b32 v3, s51
    v_mov_b32 v4, s29
    s_mov_b64 exec, 1
    global_store_dword v3, v4, s[26:27] sc1
    s_mov_b64 exec, -1
    s_branch gated_mix__softmax_full_mha__spectral_fnet__prompt_kernel_attn
gated_mix__softmax_full_mha__spectral_fnet__prompt_kernel_attn:
    s_and_b32 s48, s2, 7
    s_lshr_b32 s49, s2, 3
    s_lshl_b32 s52, s48, 2
    s_and_b32 s48, s49, 3
    s_add_u32 s52, s52, s48
    s_lshr_b32 s53, s49, 2
    s_and_b32 s55, s28, 3
    s_lshr_b32 s54, s28, 2
    s_mov_b32 s32, s26
    s_and_b32 s33, s27, 0xffff
    s_mov_b32 s34, 20971520
    s_mov_b32 s35, 0x00020000
    s_mov_b32 s57, 0
    s_lshl_b32 s60, s54, 15
    s_mul_i32 s59, s54, 34816
    v_lshrrev_b32 v3, 5, v1
    v_lshlrev_b32 v3, 8, v3
    v_and_b32 v7, 31, v1
    v_lshlrev_b32 v8, 4, v7
    v_add_u32 v8, v8, v3
    v_cmp_eq_u32 vcc, 16, v7
    v_cmp_eq_u32 s[62:63], 20, v7
    v_mov_b32 v9, 528
    v_mov_b32 v3, 512
    s_or_b64 vcc, vcc, s[62:63]
    s_nop 1
    v_cndmask_b32 v9, v9, v3, vcc
    v_cmp_gt_u32 vcc, 16, v7
    s_nop 1
    v_cndmask_b32 v8, v9, v8, vcc
    v_add_u32 v8, 65536, v8
    v_add_u32 v8, s59, v8
    v_mov_b32 v28, 0
    v_mov_b32 v29, 0
    v_mov_b32 v30, 0
    v_mov_b32 v31, 0
    v_mov_b32 v88, 0
    v_mov_b32 v89, 0
    v_mov_b32 v90, 0
    v_mov_b32 v91, 0
    v_mov_b32 v92, 0
    v_mov_b32 v93, 0
    v_mov_b32 v94, 0
    v_mov_b32 v95, 0
    v_mov_b32 v96, 0
    v_mov_b32 v97, 0
    v_mov_b32 v98, 0
    v_mov_b32 v99, 0
    v_mov_b32 v100, 0
    v_mov_b32 v101, 0
    v_mov_b32 v102, 0
    v_mov_b32 v103, 0
    v_mov_b32 v104, 0
    v_mov_b32 v105, 0
    v_mov_b32 v106, 0
    v_mov_b32 v107, 0
    v_mov_b32 v108, 0
    v_mov_b32 v109, 0
    v_mov_b32 v110, 0
    v_mov_b32 v111, 0
    v_mov_b32 v112, 0
    v_mov_b32 v113, 0
    v_mov_b32 v114, 0
    v_mov_b32 v115, 0
    v_mov_b32 v116, 0
    v_mov_b32 v117, 0
    v_mov_b32 v118, 0
    v_mov_b32 v119, 0
    v_mov_b32 v36, 0
    v_mov_b32 v37, 0
    v_mov_b32 v38, 0
    v_mov_b32 v39, 0
    v_add_u32 v7, s60, v2
    s_lshl_b32 s48, s52, 6
    s_lshl_b32 s49, s53, 3
    s_add_u32 s48, s48, s49
    s_lshl_b32 s49, s55, 1
    s_add_u32 s48, s48, s49
    s_lshl_b32 s61, s48, 10
    v_mov_b32 v3, 135168
    ds_read_b32 v4, v3
    s_waitcnt lgkmcnt(0)
    v_readfirstlane_b32 s29, v4
    s_nop 3
    v_mov_b32 v3, 135172
    s_mov_b32 s51, 1048576
gated_mix__softmax_full_mha__spectral_fnet__prompt_kernel_wgo:
    ds_read_b32 v4, v3
    s_waitcnt lgkmcnt(0)
    v_readfirstlane_b32 s48, v4
    s_sub_u32 s51, s51, 1
    s_cbranch_scc1 gated_mix__softmax_full_mha__spectral_fnet__prompt_kernel_wgo_ok
    s_nop 1
    s_cmp_ge_u32 s48, 1
    s_cbranch_scc1 gated_mix__softmax_full_mha__spectral_fnet__prompt_kernel_wgo_ok
    s_sleep 2
    s_branch gated_mix__softmax_full_mha__spectral_fnet__prompt_kernel_wgo
gated_mix__softmax_full_mha__spectral_fnet__prompt_kernel_wgo_ok:
    s_mov_b32 s59, 8192
gated_mix__softmax_full_mha__spectral_fnet__prompt_kernel_qload:
    buffer_load_dwordx4 v[12:15], v2, s[32:35], s61 offen sc1
    buffer_load_dwordx4 v[16:19], v2, s[32:35], s61 offen offset:1024 sc1
    s_waitcnt vmcnt(0)
    v_max3_u32 v9, v12, v13, v14
    v_max3_u32 v9, v9, v15, v16
    v_max3_u32 v9, v9, v17, v18
    v_max_u32 v9, v9, v19
    v_cmp_eq_u32 vcc, -1, v9
    s_nop 4
    s_cbranch_vccz gated_mix__softmax_full_mha__spectral_fnet__prompt_kernel_qok
    s_sub_u32 s59, s59, 1
    s_cbranch_scc1 gated_mix__softmax_full_mha__spectral_fnet__prompt_kernel_qok
    s_sleep 2
    s_branch gated_mix__softmax_full_mha__spectral_fnet__prompt_kernel_qload
gated_mix__softmax_full_mha__spectral_fnet__prompt_kernel_qok:
    v_mov_b32 v3, 135296
    s_mov_b32 s51, 1048576
gated_mix__softmax_full_mha__spectral_fnet__prompt_kernel_wr0:
    ds_read_b32 v4, v3
    s_waitcnt lgkmcnt(0)
    v_readfirstlane_b32 s48, v4
    s_sub_u32 s51, s51, 1
    s_cbranch_scc1 gated_mix__softmax_full_mha__spectral_fnet__prompt_kernel_wr0_ok
    s_nop 1
    s_cmp_ge_u32 s48, 1
    s_cbranch_scc1 gated_mix__softmax_full_mha__spectral_fnet__prompt_kernel_wr0_ok
    s_sleep 1
    s_branch gated_mix__softmax_full_mha__spectral_fnet__prompt_kernel_wr0
gated_mix__softmax_full_mha__spectral_fnet__prompt_kernel_wr0_ok:
    s_lshl_b32 s60, s54, 2
    s_add_u32 s60, s60, 135296
    v_mov_b32 v3, s60
    s_mov_b32 s51, 1048576
gated_mix__softmax_full_mha__spectral_fnet__prompt_kernel_wr1:
    ds_read_b32 v4, v3
    s_waitcnt lgkmcnt(0)
    v_readfirstlane_b32 s48, v4
    s_sub_u32 s51, s51, 1
    s_cbranch_scc1 gated_mix__softmax_full_mha__spectral_fnet__prompt_kernel_wr1_ok
    s_nop 1
    s_cmp_ge_u32 s48, 1
    s_cbranch_scc1 gated_mix__softmax_full_mha__spectral_fnet__prompt_kernel_wr1_ok
    s_sleep 1
    s_branch gated_mix__softmax_full_mha__spectral_fnet__prompt_kernel_wr1
gated_mix__softmax_full_mha__spectral_fnet__prompt_kernel_wr1_ok:
    v_add_u32 v10, 8, v3
    s_waitcnt vmcnt(0)
    ds_read_b128 v[72:75], v2
    ds_read_b128 v[20:23], v7
    s_waitcnt lgkmcnt(1)
    v_mfma_f32_32x32x16_bf16 v[40:55], v[72:75], v[12:15], 0
    v_mfma_f32_32x32x16_bf16 v[56:71], v[72:75], v[16:19], 0
    ds_read_b128 v[24:27], v8
    s_nop 8
    v_max3_f32 v9, v40, v41, v42
    v_max3_f32 v9, v9, v43, v44
    v_max3_f32 v9, v9, v45, v46
    v_max3_f32 v9, v9, v47, v48
    v_max3_f32 v9, v9, v49, v50
    v_max3_f32 v9, v9, v51, v52
    v_max3_f32 v9, v9, v53, v54
    v_max_f32 v9, v9, v55
    v_mov_b32 v3, v9
    s_nop 1
    v_permlane32_swap_b32 v3, v9
    s_nop 1
    v_max_f32 v9, v9, v3
    v_sub_f32 v120, 0, v9
    v_mov_b32 v121, v120
    v_mov_b32 v122, v120
    v_mov_b32 v123, v120
    v_mov_b32 v124, v120
    v_mov_b32 v125, v120
    v_mov_b32 v126, v120
    v_mov_b32 v127, v120
    v_mov_b32 v128, v120
    v_mov_b32 v129, v120
    v_mov_b32 v130, v120
    v_mov_b32 v131, v120
    v_mov_b32 v132, v120
    v_mov_b32 v133, v120
    v_mov_b32 v134, v120
    v_mov_b32 v135, v120
    s_waitcnt lgkmcnt(0)
    v_mfma_f32_32x32x16_bf16 v[40:55], v[20:23], v[12:15], v[120:135]
    v_max3_f32 v9, v56, v57, v58
    v_max3_f32 v9, v9, v59, v60
    v_max3_f32 v9, v9, v61, v62
    v_max3_f32 v9, v9, v63, v64
    v_max3_f32 v9, v9, v65, v66
    v_max3_f32 v9, v9, v67, v68
    v_max3_f32 v9, v9, v69, v70
    v_max_f32 v9, v9, v71
    v_mov_b32 v3, v9
    s_nop 1
    v_permlane32_swap_b32 v3, v9
    s_nop 1
    v_max_f32 v9, v9, v3
    v_sub_f32 v136, 0, v9
    v_mov_b32 v137, v136
    v_mov_b32 v138, v136
    v_mov_b32 v139, v136
    v_mov_b32 v140, v136
    v_mov_b32 v141, v136
    v_mov_b32 v142, v136
    v_mov_b32 v143, v136
    v_mov_b32 v144, v136
    v_mov_b32 v145, v136
    v_mov_b32 v146, v136
    v_mov_b32 v147, v136
    v_mov_b32 v148, v136
    v_mov_b32 v149, v136
    v_mov_b32 v150, v136
    v_mov_b32 v151, v136
    s_nop 1
    v_mfma_f32_32x32x16_bf16 v[56:71], v[20:23], v[16:19], v[136:151]
    ds_read_b128 v[20:23], v7 offset:1024
    s_mov_b32 s56, 0
    s_setprio 2
gated_mix__softmax_full_mha__spectral_fnet__prompt_kernel_loop:
    v_exp_f32 v72, v40
    v_exp_f32 v73, v41
    v_exp_f32 v74, v42
    v_cvt_pk_bf16_f32 v32, v72, v73
    v_exp_f32 v75, v43
    v_exp_f32 v76, v44
    v_mfma_f32_32x32x16_bf16 v[104:119], v[28:31], v[36:39], v[104:119]
    ds_read_b128 v[28:31], v8 offset:544
    v_cvt_pk_bf16_f32 v33, v74, v75
    v_exp_f32 v77, v45
    v_exp_f32 v78, v46
    v_cvt_pk_bf16_f32 v34, v76, v77
    v_exp_f32 v79, v47
    v_exp_f32 v80, v48
    v_cvt_pk_bf16_f32 v35, v78, v79
    v_exp_f32 v81, v49
    v_exp_f32 v82, v50
    s_waitcnt lgkmcnt(2)
    v_mfma_f32_32x32x16_bf16 v[88:103], v[24:27], v[32:35], v[88:103]
    v_exp_f32 v83, v51
    v_cvt_pk_bf16_f32 v36, v80, v81
    v_exp_f32 v84, v52
    v_cvt_pk_bf16_f32 v37, v82, v83
    v_exp_f32 v85, v53
    v_exp_f32 v86, v54
    v_cvt_pk_bf16_f32 v38, v84, v85
    v_exp_f32 v87, v55
    s_waitcnt lgkmcnt(1)
    v_mfma_f32_32x32x16_bf16 v[40:55], v[20:23], v[12:15], v[120:135]
    v_cvt_pk_bf16_f32 v39, v86, v87
    ds_read_b32 v11, v10
    v_exp_f32 v72, v56
    v_exp_f32 v73, v57
    v_exp_f32 v74, v58
    v_cvt_pk_bf16_f32 v32, v72, v73
    v_exp_f32 v75, v59
    v_exp_f32 v76, v60
    s_waitcnt lgkmcnt(0)
    v_mfma_f32_32x32x16_bf16 v[88:103], v[28:31], v[36:39], v[88:103]
    v_cvt_pk_bf16_f32 v33, v74, v75
    v_exp_f32 v77, v61
    v_exp_f32 v78, v62
    v_cvt_pk_bf16_f32 v34, v76, v77
    v_exp_f32 v79, v63
    v_exp_f32 v80, v64
    v_cvt_pk_bf16_f32 v35, v78, v79
    v_exp_f32 v81, v65
    v_exp_f32 v82, v66
    v_mfma_f32_32x32x16_bf16 v[104:119], v[24:27], v[32:35], v[104:119]
    ds_read_b128 v[24:27], v8 offset:1088
    v_exp_f32 v83, v67
    v_cvt_pk_bf16_f32 v36, v80, v81
    v_exp_f32 v84, v68
    v_cvt_pk_bf16_f32 v37, v82, v83
    v_exp_f32 v85, v69
    v_exp_f32 v86, v70
    v_cvt_pk_bf16_f32 v38, v84, v85
    v_exp_f32 v87, v71
    v_mfma_f32_32x32x16_bf16 v[56:71], v[20:23], v[16:19], v[136:151]
    ds_read_b128 v[20:23], v7 offset:2048
    v_cvt_pk_bf16_f32 v39, v86, v87
    v_exp_f32 v72, v40
    v_exp_f32 v73, v41
    v_exp_f32 v74, v42
    v_cvt_pk_bf16_f32 v32, v72, v73
    v_exp_f32 v75, v43
    v_exp_f32 v76, v44
    v_mfma_f32_32x32x16_bf16 v[104:119], v[28:31], v[36:39], v[104:119]
    ds_read_b128 v[28:31], v8 offset:1632
    v_cvt_pk_bf16_f32 v33, v74, v75
    v_exp_f32 v77, v45
    v_exp_f32 v78, v46
    v_cvt_pk_bf16_f32 v34, v76, v77
    v_exp_f32 v79, v47
    v_exp_f32 v80, v48
    v_cvt_pk_bf16_f32 v35, v78, v79
    v_exp_f32 v81, v49
    v_exp_f32 v82, v50
    s_waitcnt lgkmcnt(2)
    v_mfma_f32_32x32x16_bf16 v[88:103], v[24:27], v[32:35], v[88:103]
    v_exp_f32 v83, v51
    v_cvt_pk_bf16_f32 v36, v80, v81
    v_exp_f32 v84, v52
    v_cvt_pk_bf16_f32 v37, v82, v83
    v_exp_f32 v85, v53
    v_exp_f32 v86, v54
    v_cvt_pk_bf16_f32 v38, v84, v85
    v_exp_f32 v87, v55
    s_waitcnt lgkmcnt(1)
    v_mfma_f32_32x32x16_bf16 v[40:55], v[20:23], v[12:15], v[120:135]
    v_cvt_pk_bf16_f32 v39, v86, v87
    v_exp_f32 v72, v56
    v_exp_f32 v73, v57
    v_exp_f32 v74, v58
    v_cvt_pk_bf16_f32 v32, v72, v73
    v_exp_f32 v75, v59
    v_exp_f32 v76, v60
    s_waitcnt lgkmcnt(0)
    v_mfma_f32_32x32x16_bf16 v[88:103], v[28:31], v[36:39], v[88:103]
    v_cvt_pk_bf16_f32 v33, v74, v75
    v_exp_f32 v77, v61
    v_exp_f32 v78, v62
    v_cvt_pk_bf16_f32 v34, v76, v77
    v_exp_f32 v79, v63
    v_exp_f32 v80, v64
    v_cvt_pk_bf16_f32 v35, v78, v79
    v_exp_f32 v81, v65
    v_exp_f32 v82, v66
    v_mfma_f32_32x32x16_bf16 v[104:119], v[24:27], v[32:35], v[104:119]
    ds_read_b128 v[24:27], v8 offset:2176
    v_exp_f32 v83, v67
    v_cvt_pk_bf16_f32 v36, v80, v81
    v_exp_f32 v84, v68
    v_cvt_pk_bf16_f32 v37, v82, v83
    v_exp_f32 v85, v69
    v_exp_f32 v86, v70
    v_cvt_pk_bf16_f32 v38, v84, v85
    v_exp_f32 v87, v71
    v_mfma_f32_32x32x16_bf16 v[56:71], v[20:23], v[16:19], v[136:151]
    ds_read_b128 v[20:23], v7 offset:3072
    v_cvt_pk_bf16_f32 v39, v86, v87
    v_readfirstlane_b32 s48, v11
    v_add_u32 v10, 8, v10
    s_nop 2
    s_cmp_lg_u32 s48, 0
    s_cbranch_scc1 gated_mix__softmax_full_mha__spectral_fnet__prompt_kernel_nosync
    v_subrev_u32 v3, 8, v10
    s_mov_b32 s51, 1048576
gated_mix__softmax_full_mha__spectral_fnet__prompt_kernel_wrs:
    ds_read_b32 v4, v3
    s_waitcnt lgkmcnt(0)
    v_readfirstlane_b32 s48, v4
    s_sub_u32 s51, s51, 1
    s_cbranch_scc1 gated_mix__softmax_full_mha__spectral_fnet__prompt_kernel_nosync
    s_nop 1
    s_cmp_lg_u32 s48, 0
    s_cbranch_scc1 gated_mix__softmax_full_mha__spectral_fnet__prompt_kernel_nosync
    s_sleep 1
    s_branch gated_mix__softmax_full_mha__spectral_fnet__prompt_kernel_wrs
gated_mix__softmax_full_mha__spectral_fnet__prompt_kernel_nosync:
    v_exp_f32 v72, v40
    v_exp_f32 v73, v41
    v_exp_f32 v74, v42
    v_cvt_pk_bf16_f32 v32, v72, v73
    v_exp_f32 v75, v43
    v_exp_f32 v76, v44
    v_mfma_f32_32x32x16_bf16 v[104:119], v[28:31], v[36:39], v[104:119]
    ds_read_b128 v[28:31], v8 offset:2720
    v_cvt_pk_bf16_f32 v33, v74, v75
    v_exp_f32 v77, v45
    v_exp_f32 v78, v46
    v_cvt_pk_bf16_f32 v34, v76, v77
    v_exp_f32 v79, v47
    v_exp_f32 v80, v48
    v_cvt_pk_bf16_f32 v35, v78, v79
    v_exp_f32 v81, v49
    v_exp_f32 v82, v50
    s_waitcnt lgkmcnt(2)
    v_mfma_f32_32x32x16_bf16 v[88:103], v[24:27], v[32:35], v[88:103]
    v_exp_f32 v83, v51
    v_cvt_pk_bf16_f32 v36, v80, v81
    v_exp_f32 v84, v52
    v_cvt_pk_bf16_f32 v37, v82, v83
    v_exp_f32 v85, v53
    v_exp_f32 v86, v54
    v_cvt_pk_bf16_f32 v38, v84, v85
    v_exp_f32 v87, v55
    s_waitcnt lgkmcnt(1)
    v_mfma_f32_32x32x16_bf16 v[40:55], v[20:23], v[12:15], v[120:135]
    v_cvt_pk_bf16_f32 v39, v86, v87
    v_exp_f32 v72, v56
    v_exp_f32 v73, v57
    v_exp_f32 v74, v58
    v_cvt_pk_bf16_f32 v32, v72, v73
    v_exp_f32 v75, v59
    v_exp_f32 v76, v60
    s_waitcnt lgkmcnt(0)
    v_mfma_f32_32x32x16_bf16 v[88:103], v[28:31], v[36:39], v[88:103]
    v_cvt_pk_bf16_f32 v33, v74, v75
    v_exp_f32 v77, v61
    v_exp_f32 v78, v62
    v_cvt_pk_bf16_f32 v34, v76, v77
    v_exp_f32 v79, v63
    v_exp_f32 v80, v64
    v_cvt_pk_bf16_f32 v35, v78, v79
    v_exp_f32 v81, v65
    v_exp_f32 v82, v66
    v_mfma_f32_32x32x16_bf16 v[104:119], v[24:27], v[32:35], v[104:119]
    ds_read_b128 v[24:27], v8 offset:3264
    v_exp_f32 v83, v67
    v_cvt_pk_bf16_f32 v36, v80, v81
    v_exp_f32 v84, v68
    v_cvt_pk_bf16_f32 v37, v82, v83
    v_exp_f32 v85, v69
    v_exp_f32 v86, v70
    v_cvt_pk_bf16_f32 v38, v84, v85
    v_exp_f32 v87, v71
    v_mfma_f32_32x32x16_bf16 v[56:71], v[20:23], v[16:19], v[136:151]
    ds_read_b128 v[20:23], v7 offset:4096
    v_cvt_pk_bf16_f32 v39, v86, v87
    v_exp_f32 v72, v40
    v_exp_f32 v73, v41
    v_exp_f32 v74, v42
    v_cvt_pk_bf16_f32 v32, v72, v73
    v_exp_f32 v75, v43
    v_exp_f32 v76, v44
    v_mfma_f32_32x32x16_bf16 v[104:119], v[28:31], v[36:39], v[104:119]
    ds_read_b128 v[28:31], v8 offset:3808
    v_cvt_pk_bf16_f32 v33, v74, v75
    v_exp_f32 v77, v45
    v_exp_f32 v78, v46
    v_cvt_pk_bf16_f32 v34, v76, v77
    v_exp_f32 v79, v47
    v_exp_f32 v80, v48
    v_cvt_pk_bf16_f32 v35, v78, v79
    v_exp_f32 v81, v49
    v_exp_f32 v82, v50
    s_waitcnt lgkmcnt(2)
    v_mfma_f32_32x32x16_bf16 v[88:103], v[24:27], v[32:35], v[88:103]
    v_exp_f32 v83, v51
    v_cvt_pk_bf16_f32 v36, v80, v81
    v_exp_f32 v84, v52
    v_cvt_pk_bf16_f32 v37, v82, v83
    v_exp_f32 v85, v53
    v_exp_f32 v86, v54
    v_cvt_pk_bf16_f32 v38, v84, v85
    v_exp_f32 v87, v55
    s_waitcnt lgkmcnt(1)
    v_mfma_f32_32x32x16_bf16 v[40:55], v[20:23], v[12:15], v[120:135]
    v_cvt_pk_bf16_f32 v39, v86, v87
    v_exp_f32 v72, v56
    v_exp_f32 v73, v57
    v_exp_f32 v74, v58
    v_cvt_pk_bf16_f32 v32, v72, v73
    v_exp_f32 v75, v59
    v_exp_f32 v76, v60
    s_waitcnt lgkmcnt(0)
    v_mfma_f32_32x32x16_bf16 v[88:103], v[28:31], v[36:39], v[88:103]
    v_cvt_pk_bf16_f32 v33, v74, v75
    v_exp_f32 v77, v61
    v_exp_f32 v78, v62
    v_cvt_pk_bf16_f32 v34, v76, v77
    v_exp_f32 v79, v63
    v_exp_f32 v80, v64
    v_cvt_pk_bf16_f32 v35, v78, v79
    v_exp_f32 v81, v65
    v_exp_f32 v82, v66
    v_mfma_f32_32x32x16_bf16 v[104:119], v[24:27], v[32:35], v[104:119]
    ds_read_b128 v[24:27], v8 offset:4352
    v_exp_f32 v83, v67
    v_cvt_pk_bf16_f32 v36, v80, v81
    v_exp_f32 v84, v68
    v_cvt_pk_bf16_f32 v37, v82, v83
    v_exp_f32 v85, v69
    v_exp_f32 v86, v70
    v_cvt_pk_bf16_f32 v38, v84, v85
    v_exp_f32 v87, v71
    v_mfma_f32_32x32x16_bf16 v[56:71], v[20:23], v[16:19], v[136:151]
    ds_read_b128 v[20:23], v7 offset:5120
    v_cvt_pk_bf16_f32 v39, v86, v87
    v_add_u32 v7, 4096, v7
    v_add_u32 v8, 4352, v8
    s_add_u32 s56, s56, 1
    s_cmp_eq_u32 s56, 5
    s_cbranch_scc0 gated_mix__softmax_full_mha__spectral_fnet__prompt_kernel_p1
    s_setprio 1
gated_mix__softmax_full_mha__spectral_fnet__prompt_kernel_p1:
    s_cmp_eq_u32 s56, 7
    s_cbranch_scc0 gated_mix__softmax_full_mha__spectral_fnet__prompt_kernel_p2
    s_setprio 0
    v_mov_b32 v3, 135264
    v_mov_b32 v4, 1
    s_mov_b64 exec, 1
    ds_add_u32 v3, v4
    s_mov_b64 exec, -1
gated_mix__softmax_full_mha__spectral_fnet__prompt_kernel_p2:
    s_cmp_lg_u32 s56, 8
    s_cbranch_scc1 gated_mix__softmax_full_mha__spectral_fnet__prompt_kernel_loop
    s_nop 1
    v_mfma_f32_32x32x16_bf16 v[104:119], v[28:31], v[36:39], v[104:119]
    v_mov_b32 v3, 135192
    s_mov_b32 s51, 1048576
gated_mix__softmax_full_mha__spectral_fnet__prompt_kernel_wf:
    ds_read_b32 v4, v3
    s_waitcnt lgkmcnt(0)
    v_readfirstlane_b32 s48, v4
    s_sub_u32 s51, s51, 1
    s_cbranch_scc1 gated_mix__softmax_full_mha__spectral_fnet__prompt_kernel_wf_ok
    s_nop 1
    s_cmp_ge_u32 s48, 4
    s_cbranch_scc1 gated_mix__softmax_full_mha__spectral_fnet__prompt_kernel_wf_ok
    s_sleep 1
    s_branch gated_mix__softmax_full_mha__spectral_fnet__prompt_kernel_wf
gated_mix__softmax_full_mha__spectral_fnet__prompt_kernel_wf_ok:
    s_nop 8
    s_mul_i32 s48, s28, 2304
    s_add_u32 s48, s48, 135424
    v_add_u32 v3, s48, v2
    v_lshrrev_b32 v4, 2, v2
    v_add_u32 v4, s48, v4
    s_cmp_eq_u32 s54, 0
    s_cbranch_scc0 gated_mix__softmax_full_mha__spectral_fnet__prompt_kernel_x1
    ds_write_b128 v3, v[104:107]
    ds_write_b128 v3, v[108:111] offset:1024
    ds_write_b32 v4, v112 offset:2048
    s_branch gated_mix__softmax_full_mha__spectral_fnet__prompt_kernel_x2
gated_mix__softmax_full_mha__spectral_fnet__prompt_kernel_x1:
    ds_write_b128 v3, v[88:91]
    ds_write_b128 v3, v[92:95] offset:1024
    ds_write_b32 v4, v96 offset:2048
    v_mov_b32 v88, v104
    v_mov_b32 v89, v105
    v_mov_b32 v90, v106
    v_mov_b32 v91, v107
    v_mov_b32 v92, v108
    v_mov_b32 v93, v109
    v_mov_b32 v94, v110
    v_mov_b32 v95, v111
    v_mov_b32 v96, v112
    v_mov_b32 v12, v16
    v_mov_b32 v13, v17
    v_mov_b32 v14, v18
    v_mov_b32 v15, v19
gated_mix__softmax_full_mha__spectral_fnet__prompt_kernel_x2:
    s_waitcnt lgkmcnt(0)
    s_lshl_b32 s48, s55, 2
    s_add_u32 s61, s48, 135216
    v_mov_b32 v7, s61
    v_mov_b32 v9, 1
    s_mov_b64 exec, 1
    ds_add_u32 v7, v9
    s_mov_b64 exec, -1
    v_mov_b32 v7, s61
    s_mov_b32 s51, 1048576
gated_mix__softmax_full_mha__spectral_fnet__prompt_kernel_wx:
    ds_read_b32 v9, v7
    s_waitcnt lgkmcnt(0)
    v_readfirstlane_b32 s48, v9
    s_sub_u32 s51, s51, 1
    s_cbranch_scc1 gated_mix__softmax_full_mha__spectral_fnet__prompt_kernel_wx_ok
    s_nop 1
    s_cmp_ge_u32 s48, 2
    s_cbranch_scc1 gated_mix__softmax_full_mha__spectral_fnet__prompt_kernel_wx_ok
    s_sleep 1
    s_branch gated_mix__softmax_full_mha__spectral_fnet__prompt_kernel_wx
gated_mix__softmax_full_mha__spectral_fnet__prompt_kernel_wx_ok:
    s_xor_b32 s48, s28, 4
    s_mul_i32 s48, s48, 2304
    s_add_u32 s48, s48, 135424
    v_add_u32 v3, s48, v2
    v_lshrrev_b32 v4, 2, v2
    v_add_u32 v4, s48, v4
    ds_read_b128 v[72:75], v3
    ds_read_b128 v[76:79], v3 offset:1024
    ds_read_b32 v80, v4 offset:2048
    s_waitcnt lgkmcnt(0)
    v_add_f32 v88, v88, v72
    v_add_f32 v89, v89, v73
    v_add_f32 v90, v90, v74
    v_add_f32 v91, v91, v75
    v_add_f32 v92, v92, v76
    v_add_f32 v93, v93, v77
    v_add_f32 v94, v94, v78
    v_add_f32 v95, v95, v79
    v_add_f32 v96, v96, v80
gated_mix__softmax_full_mha__spectral_fnet__prompt_kernel_epi:
    s_cmp_lg_u32 s57, 0
    s_cbranch_scc1 gated_mix__softmax_full_mha__spectral_fnet__prompt_kernel_fin
    v_mov_b32 v3, 0x5d800000
    v_cmp_nle_f32 vcc, v96, v3
    s_nop 4
    s_cbranch_vccnz gated_mix__softmax_full_mha__spectral_fnet__prompt_kernel_fallback
gated_mix__softmax_full_mha__spectral_fnet__prompt_kernel_fin:
    v_rcp_f32 v3, v96
    s_nop 0
    v_mul_f32 v88, v88, v3
    v_mul_f32 v89, v89, v3
    v_mul_f32 v90, v90, v3
    v_mul_f32 v91, v91, v3
    v_mul_f32 v92, v92, v3
    v_mul_f32 v93, v93, v3
    v_mul_f32 v94, v94, v3
    v_mul_f32 v95, v95, v3
    v_cvt_pk_bf16_f32 v32, v88, v89
    v_cvt_pk_bf16_f32 v33, v90, v91
    v_cvt_pk_bf16_f32 v34, v92, v93
    v_cvt_pk_bf16_f32 v35, v94, v95
    s_lshl_b32 s48, s53, 3
    s_lshl_b32 s49, s55, 1
    s_add_u32 s48, s48, s49
    s_add_u32 s48, s48, s54
    s_lshl_b32 s48, s48, 5
    s_add_u32 s48, s48, s52
    s_lshl_b32 s48, s48, 10
    s_add_u32 s48, s48, 6291456
    buffer_store_dwordx4 v[32:35], v2, s[32:35], s48 offen sc1
    v_mov_b32 v3, 135200
    v_mov_b32 v4, 1
    s_mov_b64 exec, 1
    ds_add_u32 v3, v4
    s_mov_b64 exec, -1
gated_mix__softmax_full_mha__spectral_fnet__prompt_kernel_adone:
    s_endpgm
gated_mix__softmax_full_mha__spectral_fnet__prompt_kernel_fallback:
    s_mov_b32 s57, 1
    v_mov_b32 v7, v2
    v_mov_b32 v9, 0xff800000
    s_mov_b32 s56, 64
gated_mix__softmax_full_mha__spectral_fnet__prompt_kernel_maxloop:
    ds_read_b128 v[20:23], v7
    s_waitcnt lgkmcnt(0)
    v_mfma_f32_32x32x16_bf16 v[40:55], v[20:23], v[12:15], 0
    v_add_u32 v7, 1024, v7
    s_nop 15
    s_nop 3
    v_max3_f32 v9, v9, v40, v41
    v_max3_f32 v9, v9, v42, v43
    v_max3_f32 v9, v9, v44, v45
    v_max3_f32 v9, v9, v46, v47
    v_max3_f32 v9, v9, v48, v49
    v_max3_f32 v9, v9, v50, v51
    v_max3_f32 v9, v9, v52, v53
    v_max3_f32 v9, v9, v54, v55
    s_sub_u32 s56, s56, 1
    s_cmp_lg_u32 s56, 0
    s_cbranch_scc1 gated_mix__softmax_full_mha__spectral_fnet__prompt_kernel_maxloop
    v_mov_b32 v3, v9
    s_nop 1
    v_permlane32_swap_b32 v3, v9
    s_nop 1
    v_max_f32 v9, v9, v3
    v_sub_f32 v120, 0, v9
    v_mov_b32 v121, v120
    v_mov_b32 v122, v120
    v_mov_b32 v123, v120
    v_mov_b32 v124, v120
    v_mov_b32 v125, v120
    v_mov_b32 v126, v120
    v_mov_b32 v127, v120
    v_mov_b32 v128, v120
    v_mov_b32 v129, v120
    v_mov_b32 v130, v120
    v_mov_b32 v131, v120
    v_mov_b32 v132, v120
    v_mov_b32 v133, v120
    v_mov_b32 v134, v120
    v_mov_b32 v135, v120
    v_mov_b32 v88, 0
    v_mov_b32 v89, 0
    v_mov_b32 v90, 0
    v_mov_b32 v91, 0
    v_mov_b32 v92, 0
    v_mov_b32 v93, 0
    v_mov_b32 v94, 0
    v_mov_b32 v95, 0
    v_mov_b32 v96, 0
    v_mov_b32 v97, 0
    v_mov_b32 v98, 0
    v_mov_b32 v99, 0
    v_mov_b32 v100, 0
    v_mov_b32 v101, 0
    v_mov_b32 v102, 0
    v_mov_b32 v103, 0
    v_mov_b32 v7, v2
    s_mul_i32 s60, s54, 34816
    s_add_u32 s60, s60, 34816
    v_subrev_u32 v8, s60, v8
    s_mov_b32 s56, 64
gated_mix__softmax_full_mha__spectral_fnet__prompt_kernel_redo:
    ds_read_b128 v[20:23], v7
    ds_read_b128 v[24:27], v8
    ds_read_b128 v[28:31], v8 offset:544
    s_waitcnt lgkmcnt(0)
    v_mfma_f32_32x32x16_bf16 v[40:55], v[20:23], v[12:15], v[120:135]
    v_add_u32 v7, 1024, v7
    v_add_u32 v8, 1088, v8
    s_nop 15
    s_nop 3
    v_exp_f32 v72, v40
    v_exp_f32 v73, v41
    v_exp_f32 v74, v42
    v_exp_f32 v75, v43
    v_exp_f32 v76, v44
    v_exp_f32 v77, v45
    v_exp_f32 v78, v46
    v_exp_f32 v79, v47
    v_exp_f32 v80, v48
    v_exp_f32 v81, v49
    v_exp_f32 v82, v50
    v_exp_f32 v83, v51
    v_exp_f32 v84, v52
    v_exp_f32 v85, v53
    v_exp_f32 v86, v54
    v_exp_f32 v87, v55
    s_nop 0
    v_cvt_pk_bf16_f32 v32, v72, v73
    v_cvt_pk_bf16_f32 v33, v74, v75
    v_cvt_pk_bf16_f32 v34, v76, v77
    v_cvt_pk_bf16_f32 v35, v78, v79
    v_cvt_pk_bf16_f32 v36, v80, v81
    v_cvt_pk_bf16_f32 v37, v82, v83
    v_cvt_pk_bf16_f32 v38, v84, v85
    v_cvt_pk_bf16_f32 v39, v86, v87
    s_nop 1
    v_mfma_f32_32x32x16_bf16 v[88:103], v[24:27], v[32:35], v[88:103]
    v_mfma_f32_32x32x16_bf16 v[88:103], v[28:31], v[36:39], v[88:103]
    s_sub_u32 s56, s56, 1
    s_cmp_lg_u32 s56, 0
    s_cbranch_scc1 gated_mix__softmax_full_mha__spectral_fnet__prompt_kernel_redo
    s_nop 15
    s_nop 3
    s_branch gated_mix__softmax_full_mha__spectral_fnet__prompt_kernel_epi
gated_mix__softmax_full_mha__spectral_fnet__prompt_kernel_edge:
    s_mov_b32 s58, 0
    s_cmp_lg_u32 s30, 0
    s_cbranch_scc1 gated_mix__softmax_full_mha__spectral_fnet__prompt_kernel_pz_done
    s_cmp_ge_u32 s54, 4
    s_cbranch_scc1 gated_mix__softmax_full_mha__spectral_fnet__prompt_kernel_pz_done
    s_sub_u32 s48, s28, 8
    s_lshr_b32 s49, s48, 1
    s_lshl_b32 s49, s49, 2
    s_and_b32 s50, s54, 3
    s_lshl_b32 s50, s50, 3
    s_add_u32 s49, s49, s50
    s_lshl_b32 s49, s49, 16
    s_and_b32 s48, s48, 1
    s_lshr_b32 s50, s54, 2
    s_lshl_b32 s51, s50, 21
    s_add_u32 s49, s49, s51
    s_cmp_eq_u32 s50, 2
    s_cbranch_scc1 gated_mix__softmax_full_mha__spectral_fnet__prompt_kernel_pz_v
    s_mov_b32 s58, 1
    s_lshl_b32 s48, s48, 1
    s_lshr_b32 s50, s52, 5
    s_add_u32 s48, s48, s50
    s_lshl_b32 s48, s48, 10
    s_add_u32 s59, s48, s49
    s_branch gated_mix__softmax_full_mha__spectral_fnet__prompt_kernel_pz_done
gated_mix__softmax_full_mha__spectral_fnet__prompt_kernel_pz_v:
    s_mov_b32 s58, 2
    s_lshl_b32 s48, s48, 2
    s_lshr_b32 s50, s52, 4
    s_add_u32 s48, s48, s50
    s_lshl_b32 s48, s48, 9
    s_add_u32 s59, s48, s49
gated_mix__softmax_full_mha__spectral_fnet__prompt_kernel_pz_done:
    s_add_u32 s57, s62, 1024
    s_sub_u32 s54, s28, 8
    s_setprio 3
    v_lshlrev_b32 v3, 2, v1
    v_add_u32 v3, 135168, v3
    v_mov_b32 v4, 0
    ds_write_b32 v3, v4
    s_waitcnt lgkmcnt(0)
    s_or_b32 s48, s2, s54
    s_cmp_lg_u32 s48, 0
    s_cbranch_scc1 gated_mix__softmax_full_mha__spectral_fnet__prompt_kernel_nn
    s_memrealtime s[48:49]
    s_waitcnt lgkmcnt(0)
    s_or_b32 s48, s48, 1
    v_mov_b32 v3, 0
    v_mov_b32 v4, s48
    s_mov_b64 exec, 1
    global_store_dword v3, v4, s[24:25] sc1
    s_mov_b64 exec, -1
gated_mix__softmax_full_mha__spectral_fnet__prompt_kernel_nn:
    s_mov_b32 s32, s26
    s_and_b32 s33, s27, 0xffff
    s_mov_b32 s34, 20971520
    s_mov_b32 s35, 0x00020000
    s_mov_b32 s36, s4
    s_and_b32 s37, s5, 0xffff
    s_mov_b32 s38, 2097152
    s_mov_b32 s39, 0x00020000
    s_lshl_b32 s30, s2, 2
    s_add_u32 s30, s30, s54
    global_load_dwordx4 v[16:19], v2, s[20:21]
    s_lshl_b32 s48, s30, 10
    buffer_load_dwordx4 v[20:23], v2, s[36:39], s48 offen
    s_sub_u32 s49, 2048, s30
    s_lshl_b32 s49, s49, 10
    buffer_load_dwordx4 v[24:27], v2, s[36:39], s49 offen
    s_mov_b32 s49, 1048576
    buffer_load_dwordx4 v[32:35], v2, s[36:39], s49 offen
    s_lshl_b32 s49, s2, 10
    v_add_u32 v40, s49, v2
    global_load_dwordx4 v[36:39], v40, s[16:17]
    s_barrier
    s_barrier
    s_mov_b32 s32, s26
    s_and_b32 s33, s27, 0xffff
    s_mov_b32 s34, 20971520
    s_mov_b32 s35, 0x00020000
    s_waitcnt vmcnt(0)
    s_mov_b32 s31, 0xbf803f80
    v_dot2_f32_bf16 v40, v20, v16, 0
    v_dot2_f32_bf16 v41, v24, v16, 0
    v_dot2_f32_bf16 v42, v20, s31, 0
    v_dot2_f32_bf16 v43, v36, v32, 0
    v_dot2_f32_bf16 v44, v32, v16, 0
    v_dot2_f32_bf16 v45, v32, s31, 0
    s_nop 2
    v_dot2c_f32_bf16 v42, s31, v24
    v_dot2c_f32_bf16 v40, v21, v17
    v_dot2c_f32_bf16 v41, v25, v17
    v_dot2c_f32_bf16 v42, s31, v21
    v_dot2c_f32_bf16 v43, v37, v33
    v_dot2c_f32_bf16 v44, v33, v17
    v_dot2c_f32_bf16 v45, s31, v33
    v_dot2c_f32_bf16 v42, s31, v25
    v_dot2c_f32_bf16 v40, v22, v18
    v_dot2c_f32_bf16 v41, v26, v18
    v_dot2c_f32_bf16 v42, s31, v22
    v_dot2c_f32_bf16 v43, v38, v34
    v_dot2c_f32_bf16 v44, v34, v18
    v_dot2c_f32_bf16 v45, s31, v34
    v_dot2c_f32_bf16 v42, s31, v26
    v_dot2c_f32_bf16 v40, v23, v19
    v_dot2c_f32_bf16 v41, v27, v19
    v_dot2c_f32_bf16 v42, s31, v23
    v_dot2c_f32_bf16 v43, v39, v35
    v_dot2c_f32_bf16 v44, v35, v19
    v_dot2c_f32_bf16 v45, s31, v35
    v_dot2c_f32_bf16 v42, s31, v27
    s_nop 3
    v_add_f32_dpp v40, v40, v40 row_shr:1 row_mask:0xf bank_mask:0xf bound_ctrl:0
    v_add_f32_dpp v41, v41, v41 row_shr:1 row_mask:0xf bank_mask:0xf bound_ctrl:0
    v_add_f32_dpp v42, v42, v42 row_shr:1 row_mask:0xf bank_mask:0xf bound_ctrl:0
    v_add_f32_dpp v43, v43, v43 row_shr:1 row_mask:0xf bank_mask:0xf bound_ctrl:0
    v_add_f32_dpp v44, v44, v44 row_shr:1 row_mask:0xf bank_mask:0xf bound_ctrl:0
    v_add_f32_dpp v45, v45, v45 row_shr:1 row_mask:0xf bank_mask:0xf bound_ctrl:0
    v_add_f32_dpp v40, v40, v40 row_shr:2 row_mask:0xf bank_mask:0xf bound_ctrl:0
    v_add_f32_dpp v41, v41, v41 row_shr:2 row_mask:0xf bank_mask:0xf bound_ctrl:0
    v_add_f32_dpp v42, v42, v42 row_shr:2 row_mask:0xf bank_mask:0xf bound_ctrl:0
    v_add_f32_dpp v43, v43, v43 row_shr:2 row_mask:0xf bank_mask:0xf bound_ctrl:0
    v_add_f32_dpp v44, v44, v44 row_shr:2 row_mask:0xf bank_mask:0xf bound_ctrl:0
    v_add_f32_dpp v45, v45, v45 row_shr:2 row_mask:0xf bank_mask:0xf bound_ctrl:0
    v_add_f32_dpp v40, v40, v40 row_shr:4 row_mask:0xf bank_mask:0xf bound_ctrl:0
    v_add_f32_dpp v41, v41, v41 row_shr:4 row_mask:0xf bank_mask:0xf bound_ctrl:0
    v_add_f32_dpp v42, v42, v42 row_shr:4 row_mask:0xf bank_mask:0xf bound_ctrl:0
    v_add_f32_dpp v43, v43, v43 row_shr:4 row_mask:0xf bank_mask:0xf bound_ctrl:0
    v_add_f32_dpp v44, v44, v44 row_shr:4 row_mask:0xf bank_mask:0xf bound_ctrl:0
    v_add_f32_dpp v45, v45, v45 row_shr:4 row_mask:0xf bank_mask:0xf bound_ctrl:0
    v_add_f32_dpp v40, v40, v40 row_shr:8 row_mask:0xf bank_mask:0xf bound_ctrl:0
    v_add_f32_dpp v41, v41, v41 row_shr:8 row_mask:0xf bank_mask:0xf bound_ctrl:0
    v_add_f32_dpp v42, v42, v42 row_shr:8 row_mask:0xf bank_mask:0xf bound_ctrl:0
    v_add_f32_dpp v43, v43, v43 row_shr:8 row_mask:0xf bank_mask:0xf bound_ctrl:0
    v_add_f32_dpp v44, v44, v44 row_shr:8 row_mask:0xf bank_mask:0xf bound_ctrl:0
    v_add_f32_dpp v45, v45, v45 row_shr:8 row_mask:0xf bank_mask:0xf bound_ctrl:0
    v_add_f32_dpp v40, v40, v40 row_bcast:15 row_mask:0xa bank_mask:0xf
    v_add_f32_dpp v41, v41, v41 row_bcast:15 row_mask:0xa bank_mask:0xf
    v_add_f32_dpp v42, v42, v42 row_bcast:15 row_mask:0xa bank_mask:0xf
    v_add_f32_dpp v43, v43, v43 row_bcast:15 row_mask:0xa bank_mask:0xf
    v_add_f32_dpp v44, v44, v44 row_bcast:15 row_mask:0xa bank_mask:0xf
    v_add_f32_dpp v45, v45, v45 row_bcast:15 row_mask:0xa bank_mask:0xf
    v_add_f32_dpp v40, v40, v40 row_bcast:31 row_mask:0xc bank_mask:0xf
    v_add_f32_dpp v41, v41, v41 row_bcast:31 row_mask:0xc bank_mask:0xf
    v_add_f32_dpp v42, v42, v42 row_bcast:31 row_mask:0xc bank_mask:0xf
    v_add_f32_dpp v43, v43, v43 row_bcast:31 row_mask:0xc bank_mask:0xf
    v_add_f32_dpp v44, v44, v44 row_bcast:31 row_mask:0xc bank_mask:0xf
    v_add_f32_dpp v45, v45, v45 row_bcast:31 row_mask:0xc bank_mask:0xf
    v_mul_f32 v40, 3216550459, v40
    v_mul_f32 v41, 3216550459, v41
    v_mul_f32 v44, 3216550459, v44
    v_exp_f32 v40, v40
    v_exp_f32 v41, v41
    v_exp_f32 v44, v44
    s_nop 0
    v_add_f32 v40, 1.0, v40
    v_add_f32 v41, 1.0, v41
    v_add_f32 v44, 1.0, v44
    v_rcp_f32 v40, v40
    v_rcp_f32 v41, v41
    v_rcp_f32 v44, v44
    v_cvt_pk_bf16_f32 v42, v42, 0
    v_cvt_pk_bf16_f32 v28, v43, 0
    v_cvt_pk_bf16_f32 v45, v45, 0
    v_mov_b32 v29, 0
    v_mov_b32 v30, 0
    v_mov_b32 v31, 0
    v_mov_b32 v20, 0
    v_mov_b32 v21, 0
    v_mov_b32 v22, 0
    v_mov_b32 v23, 0
    v_mov_b32 v4, 0
    s_mov_b32 exec_lo, 0
    s_mov_b32 exec_hi, 0x80000000
    s_lshl_b32 s48, s30, 2
    s_add_u32 s48, s48, 14680064
    buffer_store_dword v40, v4, s[32:35], s48 offen sc1
    s_cmp_eq_u32 s30, 0
    s_cbranch_scc1 gated_mix__softmax_full_mha__spectral_fnet__prompt_kernel_e1p
    s_sub_u32 s48, 2048, s30
    s_lshl_b32 s48, s48, 2
    s_add_u32 s48, s48, 14680064
    buffer_store_dword v41, v4, s[32:35], s48 offen sc1
gated_mix__softmax_full_mha__spectral_fnet__prompt_kernel_e1p:
    s_lshr_b32 s48, s30, 4
    s_add_u32 s48, s48, 576
    s_lshl_b32 s48, s48, 10
    s_bfe_u32 s49, s30, 0x10003
    s_lshl_b32 s49, s49, 9
    s_add_u32 s48, s48, s49
    s_and_b32 s49, s30, 7
    s_lshl_b32 s49, s49, 1
    s_add_u32 s48, s48, s49
    s_add_u32 s48, s48, 8388608
    buffer_store_short v42, v4, s[32:35], s48 offen sc1
    s_cmp_lg_u32 s54, 0
    s_cbranch_scc1 gated_mix__softmax_full_mha__spectral_fnet__prompt_kernel_e2p
    s_lshr_b32 s48, s2, 5
    s_mul_i32 s48, s48, 72
    s_add_u32 s48, s48, 64
    s_lshl_b32 s48, s48, 10
    s_and_b32 s49, s2, 31
    s_lshl_b32 s49, s49, 4
    s_add_u32 s48, s48, s49
    s_add_u32 s48, s48, 8388608
    buffer_store_dwordx4 v[28:31], v4, s[32:35], s48 offen sc1
    buffer_store_dwordx4 v[20:23], v4, s[32:35], s48 offen offset:512 sc1
gated_mix__softmax_full_mha__spectral_fnet__prompt_kernel_e2p:
    s_cmp_lg_u32 s30, 1
    s_cbranch_scc1 gated_mix__softmax_full_mha__spectral_fnet__prompt_kernel_e3p
    s_mov_b32 s48, 14684160
    buffer_store_dword v44, v4, s[32:35], s48 offen sc1
    v_mov_b32 v28, v45
    s_mov_b32 s48, 9043968
    buffer_store_dwordx4 v[28:31], v4, s[32:35], s48 offen sc1
    buffer_store_dwordx4 v[20:23], v4, s[32:35], s48 offen offset:512 sc1
gated_mix__softmax_full_mha__spectral_fnet__prompt_kernel_e3p:
    s_mov_b64 exec, -1
    s_and_b32 s48, s2, 7
    s_lshr_b32 s49, s2, 3
    s_lshl_b32 s52, s48, 2
    s_and_b32 s48, s49, 3
    s_add_u32 s52, s52, s48
    s_lshr_b32 s53, s49, 2
    v_mov_b32 v8, -1
    v_mov_b32 v9, -1
    v_mov_b32 v10, -1
    v_mov_b32 v11, -1
    s_lshl_b32 s48, s53, 3
    s_lshl_b32 s49, s54, 1
    s_add_u32 s48, s48, s49
    s_lshl_b32 s48, s48, 5
    s_add_u32 s48, s48, s52
    s_lshl_b32 s48, s48, 10
    s_add_u32 s48, s48, 6291456
    buffer_store_dwordx4 v[8:11], v2, s[32:35], s48 offen sc1
    s_add_u32 s48, s48, 32768
    buffer_store_dwordx4 v[8:11], v2, s[32:35], s48 offen sc1
    s_cmp_eq_u32 s58, 0
    s_cbranch_scc1 gated_mix__softmax_full_mha__spectral_fnet__prompt_kernel_noqp
    s_cmp_eq_u32 s58, 2
    s_cbranch_scc1 gated_mix__softmax_full_mha__spectral_fnet__prompt_kernel_qpv
    s_add_u32 s48, s59, 0
    buffer_store_dwordx4 v[8:11], v2, s[32:35], s48 offen sc1
    s_add_u32 s48, s59, 1024
    buffer_store_dwordx4 v[8:11], v2, s[32:35], s48 offen sc1
    s_add_u32 s48, s59, 65536
    buffer_store_dwordx4 v[8:11], v2, s[32:35], s48 offen sc1
    s_add_u32 s48, s59, 66560
    buffer_store_dwordx4 v[8:11], v2, s[32:35], s48 offen sc1
    s_add_u32 s48, s59, 131072
    buffer_store_dwordx4 v[8:11], v2, s[32:35], s48 offen sc1
    s_add_u32 s48, s59, 132096
    buffer_store_dwordx4 v[8:11], v2, s[32:35], s48 offen sc1
    s_add_u32 s48, s59, 196608
    buffer_store_dwordx4 v[8:11], v2, s[32:35], s48 offen sc1
    s_add_u32 s48, s59, 197632
    buffer_store_dwordx4 v[8:11], v2, s[32:35], s48 offen sc1
    s_branch gated_mix__softmax_full_mha__spectral_fnet__prompt_kernel_noqp
gated_mix__softmax_full_mha__spectral_fnet__prompt_kernel_qpv:
    v_bfe_u32 v3, v1, 4, 1
    v_lshlrev_b32 v3, 16, v3
    v_lshrrev_b32 v4, 5, v1
    v_lshlrev_b32 v4, 8, v4
    v_add_u32 v3, v3, v4
    v_and_b32 v4, 15, v1
    v_lshlrev_b32 v4, 4, v4
    v_add_u32 v3, v3, v4
    s_add_u32 s48, s59, 0
    buffer_store_dwordx4 v[8:11], v3, s[32:35], s48 offen sc1
    s_add_u32 s48, s59, 512
    buffer_store_dwordx4 v[8:11], v3, s[32:35], s48 offen sc1
    s_add_u32 s48, s59, 1024
    buffer_store_dwordx4 v[8:11], v3, s[32:35], s48 offen sc1
    s_add_u32 s48, s59, 1536
    buffer_store_dwordx4 v[8:11], v3, s[32:35], s48 offen sc1
    s_add_u32 s48, s59, 131072
    buffer_store_dwordx4 v[8:11], v3, s[32:35], s48 offen sc1
    s_add_u32 s48, s59, 131584
    buffer_store_dwordx4 v[8:11], v3, s[32:35], s48 offen sc1
    s_add_u32 s48, s59, 132096
    buffer_store_dwordx4 v[8:11], v3, s[32:35], s48 offen sc1
    s_add_u32 s48, s59, 132608
    buffer_store_dwordx4 v[8:11], v3, s[32:35], s48 offen sc1
gated_mix__softmax_full_mha__spectral_fnet__prompt_kernel_noqp:
    s_mov_b32 s40, s57
    s_mov_b32 s41, s58
    s_mov_b32 s42, s59
    s_mov_b32 s56, s52
    s_mov_b32 s57, s53
    s_and_b32 s58, s54, 1
    s_lshr_b32 s59, s54, 1
    s_lshl_b32 s48, s58, 5
    s_lshl_b32 s60, s56, 6
    s_add_u32 s60, s60, s48
    s_lshl_b32 s48, s59, 5
    s_lshl_b32 s61, s57, 6
    s_add_u32 s61, s61, s48
    v_lshrrev_b32 v3, 3, v1
    v_lshlrev_b32 v164, 10, v3
    v_bfe_u32 v4, v1, 4, 1
    v_bfe_u32 v5, v1, 2, 1
    v_xor_b32 v4, v4, v5
    v_lshlrev_b32 v4, 6, v4
    v_add_u32 v164, v164, v4
    v_and_b32 v4, 3, v1
    v_lshlrev_b32 v4, 4, v4
    v_add_u32 v164, v164, v4
    v_bfe_u32 v3, v1, 2, 2
    v_lshrrev_b32 v4, 5, v1
    v_lshlrev_b32 v4, 2, v4
    v_add_u32 v3, v3, v4
    v_lshlrev_b32 v3, 7, v3
    v_bfe_u32 v4, v1, 4, 1
    v_lshlrev_b32 v4, 5, v4
    v_add_u32 v3, v3, v4
    v_and_b32 v4, 3, v1
    v_lshlrev_b32 v4, 3, v4
    v_add_u32 v3, v3, v4
    s_lshl_b32 s48, s59, 15
    v_add_u32 v3, s48, v3
    v_bfe_u32 v4, v1, 3, 1
    v_xor_b32 v5, 0, v4
    v_lshlrev_b32 v5, 6, v5
    v_add_u32 v160, v3, v5
    v_xor_b32 v5, 1, v4
    v_lshlrev_b32 v5, 6, v5
    v_add_u32 v161, v3, v5
    v_and_b32 v3, 31, v1
    v_add_u32 v3, s60, v3
    v_lshlrev_b32 v162, 2, v3
    v_sub_u32 v4, 2048, v3
    s_cmp_lt_u32 s60, 1024
    s_cselect_b64 vcc, -1, 0
    s_cselect_b32 s50, 1, 0
    v_cndmask_b32 v4, v4, v3, vcc
    v_mul_u32_u24 v163, 1152, v4
    v_lshrrev_b32 v4, 5, v1
    v_lshlrev_b32 v4, 4, v4
    s_cmp_lt_u32 s61, 256
    s_cselect_b32 s62, 0, 1
    s_cselect_b32 s63, 1, 0
    s_cbranch_scc0 gated_mix__softmax_full_mha__spectral_fnet__prompt_kernel_mirp
    v_add_u32 v163, v163, v4
    s_lshl_b32 s49, s61, 2
    s_branch gated_mix__softmax_full_mha__spectral_fnet__prompt_kernel_yap
gated_mix__softmax_full_mha__spectral_fnet__prompt_kernel_mirp:
    s_sub_u32 s49, 485, s61
    s_lshl_b32 s49, s49, 2
    v_add_u32 v163, s49, v163
    v_sub_u32 v163, v163, v4
    s_mov_b32 s49, 0
gated_mix__softmax_full_mha__spectral_fnet__prompt_kernel_yap:
    s_cmp_eq_u32 s50, s63
    s_mov_b32 s51, 12582912
    s_cselect_b32 s50, 10485760, s51
    s_add_u32 s63, s49, s50
    s_mov_b32 s10, s63
    s_mov_b32 s11, s62
    s_mov_b32 s57, s40
    s_mov_b32 s58, s41
    s_mov_b32 s59, s42
    s_barrier
    s_barrier
    s_barrier
    s_cmp_lg_u32 s54, 0
    s_cbranch_scc1 gated_mix__softmax_full_mha__spectral_fnet__prompt_kernel_nn2
    v_mov_b32 v3, 0
    s_mov_b32 s49, 65536
gated_mix__softmax_full_mha__spectral_fnet__prompt_kernel_npoll:
    global_load_dword v4, v3, s[24:25] sc1
    s_waitcnt vmcnt(0)
    v_readfirstlane_b32 s29, v4
    s_sub_u32 s49, s49, 1
    s_cbranch_scc1 gated_mix__softmax_full_mha__spectral_fnet__prompt_kernel_npoll_ok
    s_nop 1
    s_cmp_lg_u32 s29, 0
    s_cbranch_scc1 gated_mix__softmax_full_mha__spectral_fnet__prompt_kernel_npoll_ok
    s_sleep 1
    s_branch gated_mix__softmax_full_mha__spectral_fnet__prompt_kernel_npoll
gated_mix__softmax_full_mha__spectral_fnet__prompt_kernel_npoll_ok:
    v_mov_b32 v3, 135168
    v_mov_b32 v4, s29
    ds_write_b32 v3, v4
gated_mix__softmax_full_mha__spectral_fnet__prompt_kernel_nn2:
    s_waitcnt vmcnt(0) lgkmcnt(0)
    s_barrier
    s_cmp_eq_u32 s58, 0
    s_cbranch_scc1 gated_mix__softmax_full_mha__spectral_fnet__prompt_kernel_noqf
    s_cmp_lg_u32 s54, 0
    s_cbranch_scc1 gated_mix__softmax_full_mha__spectral_fnet__prompt_kernel_noqf
    s_lshl_b32 s51, s57, 5
    s_add_u32 s51, s51, 14745600
    v_mov_b32 v3, s51
    v_mov_b32 v4, s29
    s_mov_b64 exec, 1
    global_store_dword v3, v4, s[26:27] sc1
    s_mov_b64 exec, -1
gated_mix__softmax_full_mha__spectral_fnet__prompt_kernel_noqf:
    s_barrier
    s_barrier
    s_barrier
    s_and_b32 s48, s2, 7
    s_lshr_b32 s49, s2, 3
    s_lshl_b32 s52, s48, 2
    s_and_b32 s48, s49, 3
    s_add_u32 s52, s52, s48
    s_lshr_b32 s53, s49, 2
    s_mov_b32 s30, 0
    s_lshl_b32 s56, s52, 16
    s_add_u32 s56, s56, 2097152
    s_cmp_lg_u32 s54, 0
    s_cbranch_scc1 gated_mix__softmax_full_mha__spectral_fnet__prompt_kernel_kvld
    s_add_u32 s48, s2, 512
    s_lshl_b32 s51, s48, 5
    s_add_u32 s51, s51, 14745600
    v_mov_b32 v3, s51
    v_mov_b32 v4, s29
    s_mov_b64 exec, 1
    global_store_dword v3, v4, s[26:27] sc1
    s_mov_b64 exec, -1
    s_lshr_b32 s48, s52, 3
    s_lshl_b32 s48, s48, 4
    v_and_b32 v3, 15, v1
    v_bfe_u32 v4, v1, 4, 1
    v_lshlrev_b32 v4, 6, v4
    v_add_u32 v3, v3, v4
    v_add_u32 v3, 64, v3
    v_and_b32 v4, 1, v1
    s_lshl_b32 s49, s53, 1
    s_add_u32 s49, s49, 1024
    v_add_u32 v4, s49, v4
    v_cmp_gt_u32 vcc, 32, v1
    s_nop 1
    v_cndmask_b32 v3, v4, v3, vcc
    v_add_u32 v3, s48, v3
    v_lshlrev_b32 v9, 5, v3
    v_add_u32 v9, 14745600, v9
    s_mov_b32 s60, 0xffff
    s_mov_b32 s61, 0
    s_mov_b32 s62, 0
    s_mov_b32 s31, 65536
gated_mix__softmax_full_mha__spectral_fnet__prompt_kernel_dpoll:
    global_load_dword v3, v9, s[26:27] sc1
    s_waitcnt vmcnt(0)
    v_cmp_eq_u32 vcc, s29, v3
    s_sub_u32 s31, s31, 1
    s_cbranch_scc0 gated_mix__softmax_full_mha__spectral_fnet__prompt_kernel_dnt
    s_mov_b64 vcc, -1
gated_mix__softmax_full_mha__spectral_fnet__prompt_kernel_dnt:
    s_nop 2
    s_mov_b32 s56, vcc_lo
    s_mov_b32 s57, vcc_hi
    s_cmp_lg_u32 s61, 0
    s_cbranch_scc1 gated_mix__softmax_full_mha__spectral_fnet__prompt_kernel_dq
    s_cmp_lg_u32 s57, -1
    s_cbranch_scc1 gated_mix__softmax_full_mha__spectral_fnet__prompt_kernel_dq
    s_mov_b32 s61, 1
    v_mov_b32 v3, 135172
    v_mov_b32 v4, 1
    s_mov_b64 exec, 1
    ds_add_u32 v3, v4
    s_mov_b64 exec, -1
gated_mix__softmax_full_mha__spectral_fnet__prompt_kernel_dq:
    s_lshr_b32 s48, s56, 16
    s_and_b32 s48, s48, s56
    s_and_b32 s48, s48, s60
    s_cmp_eq_u32 s48, 0
    s_cbranch_scc1 gated_mix__softmax_full_mha__spectral_fnet__prompt_kernel_dnone
    s_andn2_b32 s60, s60, s48
gated_mix__softmax_full_mha__spectral_fnet__prompt_kernel_dq1:
    s_ff1_i32_b32 s49, s48
    s_bitset0_b32 s48, s49
    s_add_u32 s49, s49, 1
    s_lshl_b32 s50, s62, 2
    s_add_u32 s50, s50, 135360
    v_mov_b32 v3, s50
    v_mov_b32 v4, s49
    ds_write_b32 v3, v4
    s_add_u32 s62, s62, 1
    s_cmp_lg_u32 s48, 0
    s_cbranch_scc1 gated_mix__softmax_full_mha__spectral_fnet__prompt_kernel_dq1
gated_mix__softmax_full_mha__spectral_fnet__prompt_kernel_dnone:
    s_cmp_eq_u32 s61, 0
    s_cbranch_scc1 gated_mix__softmax_full_mha__spectral_fnet__prompt_kernel_dagain
    s_cmp_eq_u32 s60, 0
    s_cbranch_scc1 gated_mix__softmax_full_mha__spectral_fnet__prompt_kernel_kvdone
gated_mix__softmax_full_mha__spectral_fnet__prompt_kernel_dagain:
    s_sleep 4
    s_branch gated_mix__softmax_full_mha__spectral_fnet__prompt_kernel_dpoll
gated_mix__softmax_full_mha__spectral_fnet__prompt_kernel_kvld:
    v_mov_b32 v3, 135168
    ds_read_b32 v4, v3
    s_waitcnt lgkmcnt(0)
    v_readfirstlane_b32 s29, v4
    s_nop 3
    v_lshrrev_b32 v3, 5, v1
    v_mul_u32_u24 v3, 544, v3
    v_and_b32 v4, 31, v1
    v_lshlrev_b32 v4, 4, v4
    v_add_u32 v52, v3, v4
    v_lshrrev_b32 v3, 1, v1
    v_mul_u32_u24 v3, 544, v3
    v_and_b32 v4, 1, v1
    v_lshlrev_b32 v5, 4, v4
    v_add_u32 v3, v3, v5
    v_add_u32 v53, 512, v3
    v_cmp_eq_u32 vcc, 0, v4
    v_mov_b32 v3, 0x3f803f80
    s_nop 0
    v_cndmask_b32 v56, 0, v3, vcc
    v_cndmask_b32 v57, 0, v3, vcc
    v_cndmask_b32 v58, 0, v3, vcc
    v_cndmask_b32 v59, 0, v3, vcc
    s_sub_u32 s62, s54, 1
gated_mix__softmax_full_mha__spectral_fnet__prompt_kernel_kvnext:
    s_lshl_b32 s50, s62, 2
    s_add_u32 s63, s50, 135360
    v_mov_b32 v3, s63
    s_mov_b32 s51, 1048576
gated_mix__softmax_full_mha__spectral_fnet__prompt_kernel_kvwq:
    ds_read_b32 v4, v3
    s_waitcnt lgkmcnt(0)
    v_readfirstlane_b32 s48, v4
    s_sub_u32 s51, s51, 1
    s_cbranch_scc1 gated_mix__softmax_full_mha__spectral_fnet__prompt_kernel_kvwq_ok
    s_nop 1
    s_cmp_ge_u32 s48, 1
    s_cbranch_scc1 gated_mix__softmax_full_mha__spectral_fnet__prompt_kernel_kvwq_ok
    s_sleep 1
    s_branch gated_mix__softmax_full_mha__spectral_fnet__prompt_kernel_kvwq
gated_mix__softmax_full_mha__spectral_fnet__prompt_kernel_kvwq_ok:
    s_sub_u32 s48, s48, 1
    s_and_b32 s48, s48, 15
    s_lshl_b32 s48, s48, 12
    s_add_u32 s48, s48, s56
    s_add_u32 s49, s48, 0
    buffer_load_dwordx4 v[12:15], v2, s[32:35], s49 offen sc1
    s_add_u32 s49, s49, 2097152
    buffer_load_dwordx4 v[28:31], v2, s[32:35], s49 offen sc1
    s_add_u32 s49, s48, 1024
    buffer_load_dwordx4 v[16:19], v2, s[32:35], s49 offen sc1
    s_add_u32 s49, s49, 2097152
    buffer_load_dwordx4 v[32:35], v2, s[32:35], s49 offen sc1
    s_add_u32 s49, s48, 2048
    buffer_load_dwordx4 v[20:23], v2, s[32:35], s49 offen sc1
    s_add_u32 s49, s49, 2097152
    buffer_load_dwordx4 v[36:39], v2, s[32:35], s49 offen sc1
    s_add_u32 s49, s48, 3072
    buffer_load_dwordx4 v[24:27], v2, s[32:35], s49 offen sc1
    s_add_u32 s49, s49, 2097152
    buffer_load_dwordx4 v[40:43], v2, s[32:35], s49 offen sc1
    s_and_b32 s49, s62, 1
    s_lshr_b32 s50, s62, 1
    s_mul_i32 s58, s49, 34816
    s_mul_i32 s59, s50, 4352
    s_add_u32 s58, s58, s59
    s_add_u32 s58, s58, 65536
    s_lshl_b32 s49, s49, 15
    s_lshl_b32 s50, s50, 12
    s_add_u32 s49, s49, s50
    v_add_u32 v5, s49, v2
    v_add_u32 v6, s58, v52
    v_add_u32 v54, s58, v53
    s_lshl_b32 s48, s62, 2
    s_add_u32 s48, s48, 135296
    v_mov_b32 v3, s48
    v_mov_b32 v4, 1
    s_mov_b32 exec_lo, 0xffff
    s_mov_b32 exec_hi, 0
    ds_write_b128 v54, v[56:59]
    s_mov_b64 exec, -1
    s_waitcnt vmcnt(0)
    ds_write_b128 v5, v[12:15] offset:0
    ds_write_b128 v6, v[28:31] offset:0
    ds_write_b128 v5, v[16:19] offset:1024
    ds_write_b128 v6, v[32:35] offset:1088
    ds_write_b128 v5, v[20:23] offset:2048
    ds_write_b128 v6, v[36:39] offset:2176
    ds_write_b128 v5, v[24:27] offset:3072
    ds_write_b128 v6, v[40:43] offset:3264
    s_waitcnt lgkmcnt(0)
    ds_write_b32 v3, v4
    s_cmp_lg_u32 s30, 1
    s_cbranch_scc1 gated_mix__softmax_full_mha__spectral_fnet__prompt_kernel_kvne
    s_cmp_ge_u32 s54, 3
    s_cbranch_scc1 gated_mix__softmax_full_mha__spectral_fnet__prompt_kernel_kvne
    v_and_b32 v3, 31, v1
    s_lshl_b32 s48, s52, 5
    v_add_u32 v3, s48, v3
    v_lshlrev_b32 v3, 12, v3
    v_lshrrev_b32 v4, 5, v1
    s_lshl_b32 s48, s53, 1
    v_add_u32 v4, s48, v4
    v_lshlrev_b32 v4, 7, v4
    v_add_u32 v3, v3, v4
    s_cmp_eq_u32 s54, 1
    s_cselect_b32 s48, s12, s14
    s_cselect_b32 s49, s13, s15
    global_load_dword v108, v3, s[48:49]
gated_mix__softmax_full_mha__spectral_fnet__prompt_kernel_kvne:
    s_add_u32 s30, s30, 1
    s_add_u32 s62, s62, 3
    s_cmp_lt_u32 s62, 16
    s_cbranch_scc1 gated_mix__softmax_full_mha__spectral_fnet__prompt_kernel_kvnext
gated_mix__softmax_full_mha__spectral_fnet__prompt_kernel_kvdone:
    s_setprio 3
    s_mov_b32 s36, s12
    s_and_b32 s37, s13, 0xffff
    s_mov_b32 s38, 8388608
    s_mov_b32 s39, 0x00020000
    s_mov_b32 s40, s14
    s_and_b32 s41, s15, 0xffff
    s_mov_b32 s42, 8388608
    s_mov_b32 s43, 0x00020000
    s_mov_b32 s44, s8
    s_and_b32 s45, s9, 0xffff
    s_mov_b32 s46, 524288
    s_mov_b32 s47, 0x00020000
    s_lshl_b32 s48, s53, 7
    s_lshl_b32 s49, s54, 17
    s_add_u32 s48, s48, s49
    v_lshlrev_b32 v3, 10, v1
    buffer_load_dword v6, v3, s[44:47], s48 offen
    s_add_u32 s48, s48, 65536
    buffer_load_dword v6, v3, s[44:47], s48 offen
    s_cmp_lg_u32 s54, 0
    s_cbranch_scc1 gated_mix__softmax_full_mha__spectral_fnet__prompt_kernel_fnz2
    v_lshlrev_b32 v9, 5, v1
    v_add_u32 v9, 14753792, v9
    s_mov_b32 s31, 65536
gated_mix__softmax_full_mha__spectral_fnet__prompt_kernel_g1:
    global_load_dword v44, v9, s[26:27] sc1
    v_add_u32 v52, 8192, v9
    global_load_dword v45, v52, s[26:27] sc1
    v_add_u32 v52, 10240, v9
    global_load_dword v46, v52, s[26:27] sc1
    v_add_u32 v52, 12288, v9
    global_load_dword v47, v52, s[26:27] sc1
    v_add_u32 v52, 14336, v9
    global_load_dword v48, v52, s[26:27] sc1
    s_waitcnt vmcnt(0)
    v_cmp_ne_u32 vcc, s29, v44
    v_cmp_ne_u32 s[48:49], s29, v45
    s_nop 1
    s_or_b64 vcc, vcc, s[48:49]
    v_cmp_ne_u32 s[48:49], s29, v46
    s_nop 1
    s_or_b64 vcc, vcc, s[48:49]
    v_cmp_ne_u32 s[48:49], s29, v47
    s_nop 1
    s_or_b64 vcc, vcc, s[48:49]
    v_cmp_ne_u32 s[48:49], s29, v48
    s_nop 1
    s_or_b64 vcc, vcc, s[48:49]
    s_sub_u32 s31, s31, 1
    s_cbranch_scc1 gated_mix__softmax_full_mha__spectral_fnet__prompt_kernel_g1_ok
    s_nop 2
    s_cbranch_vccz gated_mix__softmax_full_mha__spectral_fnet__prompt_kernel_g1_ok
    s_sleep 8
    s_branch gated_mix__softmax_full_mha__spectral_fnet__prompt_kernel_g1
gated_mix__softmax_full_mha__spectral_fnet__prompt_kernel_g1_ok:
    v_mov_b32 v3, 135184
    v_mov_b32 v4, 1
    s_mov_b64 exec, 1
    ds_add_u32 v3, v4
    s_mov_b64 exec, -1
    s_branch gated_mix__softmax_full_mha__spectral_fnet__prompt_kernel_fgo2
gated_mix__softmax_full_mha__spectral_fnet__prompt_kernel_fnz2:
    v_mov_b32 v3, 135184
    s_mov_b32 s51, 1048576
gated_mix__softmax_full_mha__spectral_fnet__prompt_kernel_fwgo2:
    ds_read_b32 v4, v3
    s_waitcnt lgkmcnt(0)
    v_readfirstlane_b32 s48, v4
    s_sub_u32 s51, s51, 1
    s_cbranch_scc1 gated_mix__softmax_full_mha__spectral_fnet__prompt_kernel_fwgo2_ok
    s_nop 1
    s_cmp_ge_u32 s48, 1
    s_cbranch_scc1 gated_mix__softmax_full_mha__spectral_fnet__prompt_kernel_fwgo2_ok
    s_sleep 24
    s_branch gated_mix__softmax_full_mha__spectral_fnet__prompt_kernel_fwgo2
gated_mix__softmax_full_mha__spectral_fnet__prompt_kernel_fwgo2_ok:
gated_mix__softmax_full_mha__spectral_fnet__prompt_kernel_fgo2:
    s_mov_b32 s58, s52
    s_mov_b32 s59, s53
    v_and_b32 v3, 31, v1
    s_lshl_b32 s48, s58, 5
    v_add_u32 v3, s48, v3
    v_mul_u32_u24 v8, 1152, v3
    v_lshlrev_b32 v3, 12, v3
    v_lshrrev_b32 v4, 5, v1
    v_lshlrev_b32 v4, 4, v4
    v_add_u32 v7, v3, v4
    v_add_u32 v8, v8, v4
    s_lshl_b32 s63, s54, 4
    s_mul_i32 s61, s59, 72
    s_add_u32 s61, s61, s63
    s_lshl_b32 s61, s61, 10
    s_add_u32 s61, s61, 8388608
    s_add_u32 s60, s63, 576
    s_lshl_b32 s60, s60, 10
    s_add_u32 s60, s60, 8388608
    s_mul_i32 s62, s59, 64
    s_add_u32 s62, s62, s63
    s_lshl_b32 s62, s62, 10
    s_add_u32 s62, s62, 9437184
    s_lshl_b32 s63, s63, 5
    s_cmp_eq_u32 s59, 0
    s_cselect_b32 s30, 1, 0
    s_cmp_eq_u32 s58, 0
    s_cselect_b32 s48, 2, 0
    s_or_b32 s30, s30, s48
    s_cmp_eq_u32 s2, 8
    s_cselect_b32 s48, 4, 0
    s_or_b32 s30, s30, s48
    s_cmp_eq_u32 s30, 0
    s_cbranch_scc1 gated_mix__softmax_full_mha__spectral_fnet__prompt_kernel_noxw
    v_mov_b32 v44, 0
    v_mov_b32 v60, 0
    v_mov_b32 v45, 0
    v_mov_b32 v61, 0
    v_mov_b32 v46, 0
    v_mov_b32 v62, 0
    v_mov_b32 v47, 0
    v_mov_b32 v63, 0
    v_mov_b32 v48, 0
    v_mov_b32 v64, 0
    v_mov_b32 v49, 0
    v_mov_b32 v65, 0
    v_mov_b32 v50, 0
    v_mov_b32 v66, 0
    v_mov_b32 v51, 0
    v_mov_b32 v67, 0
    v_mov_b32 v52, 0
    v_mov_b32 v68, 0
    v_mov_b32 v53, 0
    v_mov_b32 v69, 0
    v_mov_b32 v54, 0
    v_mov_b32 v70, 0
    v_mov_b32 v55, 0
    v_mov_b32 v71, 0
    v_mov_b32 v56, 0
    v_mov_b32 v72, 0
    v_mov_b32 v57, 0
    v_mov_b32 v73, 0
    v_mov_b32 v58, 0
    v_mov_b32 v74, 0
    v_mov_b32 v59, 0
    v_mov_b32 v75, 0
    v_mov_b32 v156, 0xbf803f80
    v_mov_b32 v157, 0xbf803f80
    v_mov_b32 v158, 0xbf803f80
    v_mov_b32 v159, 0xbf803f80
gated_mix__softmax_full_mha__spectral_fnet__prompt_kernel_noxw:
    s_add_u32 s48, s61, 0
    buffer_load_dwordx4 v[76:79], v2, s[32:35], s48 offen sc1
    s_add_u32 s48, s63, 0
    buffer_load_dwordx4 v[80:83], v7, s[36:39], s48 offen
    s_add_u32 s48, s60, 0
    buffer_load_dwordx4 v[92:95], v2, s[32:35], s48 offen sc1
    s_add_u32 s48, s62, 0
    buffer_load_dwordx4 v[84:87], v2, s[32:35], s48 offen sc1
    s_add_u32 s48, s63, 0
    buffer_load_dwordx4 v[88:91], v7, s[40:43], s48 offen
    s_add_u32 s48, s61, 1024
    buffer_load_dwordx4 v[96:99], v2, s[32:35], s48 offen sc1
    s_add_u32 s48, s63, 32
    buffer_load_dwordx4 v[100:103], v7, s[36:39], s48 offen
    s_add_u32 s48, s60, 1024
    buffer_load_dwordx4 v[112:115], v2, s[32:35], s48 offen sc1
    s_add_u32 s48, s62, 1024
    buffer_load_dwordx4 v[104:107], v2, s[32:35], s48 offen sc1
    s_add_u32 s48, s63, 32
    buffer_load_dwordx4 v[108:111], v7, s[40:43], s48 offen
    s_add_u32 s48, s61, 2048
    buffer_load_dwordx4 v[116:119], v2, s[32:35], s48 offen sc1
    s_add_u32 s48, s63, 64
    buffer_load_dwordx4 v[120:123], v7, s[36:39], s48 offen
    s_add_u32 s48, s60, 2048
    buffer_load_dwordx4 v[132:135], v2, s[32:35], s48 offen sc1
    s_add_u32 s48, s62, 2048
    buffer_load_dwordx4 v[124:127], v2, s[32:35], s48 offen sc1
    s_add_u32 s48, s63, 64
    buffer_load_dwordx4 v[128:131], v7, s[40:43], s48 offen
    s_add_u32 s48, s61, 3072
    buffer_load_dwordx4 v[136:139], v2, s[32:35], s48 offen sc1
    s_add_u32 s48, s63, 96
    buffer_load_dwordx4 v[140:143], v7, s[36:39], s48 offen
    s_add_u32 s48, s60, 3072
    buffer_load_dwordx4 v[152:155], v2, s[32:35], s48 offen sc1
    s_add_u32 s48, s62, 3072
    buffer_load_dwordx4 v[144:147], v2, s[32:35], s48 offen sc1
    s_add_u32 s48, s63, 96
    buffer_load_dwordx4 v[148:151], v7, s[40:43], s48 offen
    s_waitcnt vmcnt(15)
    v_mfma_f32_32x32x16_bf16 v[12:27], v[76:79], v[80:83], 0
    v_mfma_f32_32x32x16_bf16 v[28:43], v[84:87], v[88:91], 0
    s_cmp_eq_u32 s30, 0
    s_cbranch_scc1 gated_mix__softmax_full_mha__spectral_fnet__prompt_kernel_fm1c
    s_bitcmp1_b32 s30, 0
    s_cbranch_scc0 gated_mix__softmax_full_mha__spectral_fnet__prompt_kernel_fm1a
    v_mfma_f32_32x32x16_bf16 v[44:59], v[92:95], v[80:83], v[44:59]
gated_mix__softmax_full_mha__spectral_fnet__prompt_kernel_fm1a:
    s_bitcmp1_b32 s30, 1
    s_cbranch_scc0 gated_mix__softmax_full_mha__spectral_fnet__prompt_kernel_fm1b
    v_mfma_f32_32x32x16_bf16 v[60:75], v[76:79], v[156:159], v[60:75]
gated_mix__softmax_full_mha__spectral_fnet__prompt_kernel_fm1b:
    s_bitcmp1_b32 s30, 2
    s_cbranch_scc0 gated_mix__softmax_full_mha__spectral_fnet__prompt_kernel_fm1c
    v_mfma_f32_32x32x16_bf16 v[60:75], v[92:95], v[156:159], v[60:75]
gated_mix__softmax_full_mha__spectral_fnet__prompt_kernel_fm1c:
    s_nop 4
    s_add_u32 s48, s61, 4096
    buffer_load_dwordx4 v[76:79], v2, s[32:35], s48 offen sc1
    s_add_u32 s48, s63, 128
    buffer_load_dwordx4 v[80:83], v7, s[36:39], s48 offen
    s_add_u32 s48, s60, 4096
    buffer_load_dwordx4 v[92:95], v2, s[32:35], s48 offen sc1
    s_add_u32 s48, s62, 4096
    buffer_load_dwordx4 v[84:87], v2, s[32:35], s48 offen sc1
    s_add_u32 s48, s63, 128
    buffer_load_dwordx4 v[88:91], v7, s[40:43], s48 offen
    s_waitcnt vmcnt(15)
    v_mfma_f32_32x32x16_bf16 v[12:27], v[96:99], v[100:103], v[12:27]
    v_mfma_f32_32x32x16_bf16 v[28:43], v[104:107], v[108:111], v[28:43]
    s_cmp_eq_u32 s30, 0
    s_cbranch_scc1 gated_mix__softmax_full_mha__spectral_fnet__prompt_kernel_fm2c
    s_bitcmp1_b32 s30, 0
    s_cbranch_scc0 gated_mix__softmax_full_mha__spectral_fnet__prompt_kernel_fm2a
    v_mfma_f32_32x32x16_bf16 v[44:59], v[112:115], v[100:103], v[44:59]
gated_mix__softmax_full_mha__spectral_fnet__prompt_kernel_fm2a:
    s_bitcmp1_b32 s30, 1
    s_cbranch_scc0 gated_mix__softmax_full_mha__spectral_fnet__prompt_kernel_fm2b
    v_mfma_f32_32x32x16_bf16 v[60:75], v[96:99], v[156:159], v[60:75]
gated_mix__softmax_full_mha__spectral_fnet__prompt_kernel_fm2b:
    s_bitcmp1_b32 s30, 2
    s_cbranch_scc0 gated_mix__softmax_full_mha__spectral_fnet__prompt_kernel_fm2c
    v_mfma_f32_32x32x16_bf16 v[60:75], v[112:115], v[156:159], v[60:75]
gated_mix__softmax_full_mha__spectral_fnet__prompt_kernel_fm2c:
    s_nop 4
    s_add_u32 s48, s61, 5120
    buffer_load_dwordx4 v[96:99], v2, s[32:35], s48 offen sc1
    s_add_u32 s48, s63, 160
    buffer_load_dwordx4 v[100:103], v7, s[36:39], s48 offen
    s_add_u32 s48, s60, 5120
    buffer_load_dwordx4 v[112:115], v2, s[32:35], s48 offen sc1
    s_add_u32 s48, s62, 5120
    buffer_load_dwordx4 v[104:107], v2, s[32:35], s48 offen sc1
    s_add_u32 s48, s63, 160
    buffer_load_dwordx4 v[108:111], v7, s[40:43], s48 offen
    s_waitcnt vmcnt(15)
    v_mfma_f32_32x32x16_bf16 v[12:27], v[116:119], v[120:123], v[12:27]
    v_mfma_f32_32x32x16_bf16 v[28:43], v[124:127], v[128:131], v[28:43]
    s_cmp_eq_u32 s30, 0
    s_cbranch_scc1 gated_mix__softmax_full_mha__spectral_fnet__prompt_kernel_fm3c
    s_bitcmp1_b32 s30, 0
    s_cbranch_scc0 gated_mix__softmax_full_mha__spectral_fnet__prompt_kernel_fm3a
    v_mfma_f32_32x32x16_bf16 v[44:59], v[132:135], v[120:123], v[44:59]
gated_mix__softmax_full_mha__spectral_fnet__prompt_kernel_fm3a:
    s_bitcmp1_b32 s30, 1
    s_cbranch_scc0 gated_mix__softmax_full_mha__spectral_fnet__prompt_kernel_fm3b
    v_mfma_f32_32x32x16_bf16 v[60:75], v[116:119], v[156:159], v[60:75]
gated_mix__softmax_full_mha__spectral_fnet__prompt_kernel_fm3b:
    s_bitcmp1_b32 s30, 2
    s_cbranch_scc0 gated_mix__softmax_full_mha__spectral_fnet__prompt_kernel_fm3c
    v_mfma_f32_32x32x16_bf16 v[60:75], v[132:135], v[156:159], v[60:75]
gated_mix__softmax_full_mha__spectral_fnet__prompt_kernel_fm3c:
    s_nop 4
    s_add_u32 s48, s61, 6144
    buffer_load_dwordx4 v[116:119], v2, s[32:35], s48 offen sc1
    s_add_u32 s48, s63, 192
    buffer_load_dwordx4 v[120:123], v7, s[36:39], s48 offen
    s_add_u32 s48, s60, 6144
    buffer_load_dwordx4 v[132:135], v2, s[32:35], s48 offen sc1
    s_add_u32 s48, s62, 6144
    buffer_load_dwordx4 v[124:127], v2, s[32:35], s48 offen sc1
    s_add_u32 s48, s63, 192
    buffer_load_dwordx4 v[128:131], v7, s[40:43], s48 offen
    s_waitcnt vmcnt(15)
    v_mfma_f32_32x32x16_bf16 v[12:27], v[136:139], v[140:143], v[12:27]
    v_mfma_f32_32x32x16_bf16 v[28:43], v[144:147], v[148:151], v[28:43]
    s_cmp_eq_u32 s30, 0
    s_cbranch_scc1 gated_mix__softmax_full_mha__spectral_fnet__prompt_kernel_fm4c
    s_bitcmp1_b32 s30, 0
    s_cbranch_scc0 gated_mix__softmax_full_mha__spectral_fnet__prompt_kernel_fm4a
    v_mfma_f32_32x32x16_bf16 v[44:59], v[152:155], v[140:143], v[44:59]
gated_mix__softmax_full_mha__spectral_fnet__prompt_kernel_fm4a:
    s_bitcmp1_b32 s30, 1
    s_cbranch_scc0 gated_mix__softmax_full_mha__spectral_fnet__prompt_kernel_fm4b
    v_mfma_f32_32x32x16_bf16 v[60:75], v[136:139], v[156:159], v[60:75]
gated_mix__softmax_full_mha__spectral_fnet__prompt_kernel_fm4b:
    s_bitcmp1_b32 s30, 2
    s_cbranch_scc0 gated_mix__softmax_full_mha__spectral_fnet__prompt_kernel_fm4c
    v_mfma_f32_32x32x16_bf16 v[60:75], v[152:155], v[156:159], v[60:75]
gated_mix__softmax_full_mha__spectral_fnet__prompt_kernel_fm4c:
    s_nop 4
    s_add_u32 s48, s61, 7168
    buffer_load_dwordx4 v[136:139], v2, s[32:35], s48 offen sc1
    s_add_u32 s48, s63, 224
    buffer_load_dwordx4 v[140:143], v7, s[36:39], s48 offen
    s_add_u32 s48, s60, 7168
    buffer_load_dwordx4 v[152:155], v2, s[32:35], s48 offen sc1
    s_add_u32 s48, s62, 7168
    buffer_load_dwordx4 v[144:147], v2, s[32:35], s48 offen sc1
    s_add_u32 s48, s63, 224
    buffer_load_dwordx4 v[148:151], v7, s[40:43], s48 offen
    s_waitcnt vmcnt(15)
    v_mfma_f32_32x32x16_bf16 v[12:27], v[76:79], v[80:83], v[12:27]
    v_mfma_f32_32x32x16_bf16 v[28:43], v[84:87], v[88:91], v[28:43]
    s_cmp_eq_u32 s30, 0
    s_cbranch_scc1 gated_mix__softmax_full_mha__spectral_fnet__prompt_kernel_fm5c
    s_bitcmp1_b32 s30, 0
    s_cbranch_scc0 gated_mix__softmax_full_mha__spectral_fnet__prompt_kernel_fm5a
    v_mfma_f32_32x32x16_bf16 v[44:59], v[92:95], v[80:83], v[44:59]
gated_mix__softmax_full_mha__spectral_fnet__prompt_kernel_fm5a:
    s_bitcmp1_b32 s30, 1
    s_cbranch_scc0 gated_mix__softmax_full_mha__spectral_fnet__prompt_kernel_fm5b
    v_mfma_f32_32x32x16_bf16 v[60:75], v[76:79], v[156:159], v[60:75]
gated_mix__softmax_full_mha__spectral_fnet__prompt_kernel_fm5b:
    s_bitcmp1_b32 s30, 2
    s_cbranch_scc0 gated_mix__softmax_full_mha__spectral_fnet__prompt_kernel_fm5c
    v_mfma_f32_32x32x16_bf16 v[60:75], v[92:95], v[156:159], v[60:75]
gated_mix__softmax_full_mha__spectral_fnet__prompt_kernel_fm5c:
    s_nop 4
    s_add_u32 s48, s61, 8192
    buffer_load_dwordx4 v[76:79], v2, s[32:35], s48 offen sc1
    s_add_u32 s48, s63, 256
    buffer_load_dwordx4 v[80:83], v7, s[36:39], s48 offen
    s_add_u32 s48, s60, 8192
    buffer_load_dwordx4 v[92:95], v2, s[32:35], s48 offen sc1
    s_add_u32 s48, s62, 8192
    buffer_load_dwordx4 v[84:87], v2, s[32:35], s48 offen sc1
    s_add_u32 s48, s63, 256
    buffer_load_dwordx4 v[88:91], v7, s[40:43], s48 offen
    s_waitcnt vmcnt(15)
    v_mfma_f32_32x32x16_bf16 v[12:27], v[96:99], v[100:103], v[12:27]
    v_mfma_f32_32x32x16_bf16 v[28:43], v[104:107], v[108:111], v[28:43]
    s_cmp_eq_u32 s30, 0
    s_cbranch_scc1 gated_mix__softmax_full_mha__spectral_fnet__prompt_kernel_fm6c
    s_bitcmp1_b32 s30, 0
    s_cbranch_scc0 gated_mix__softmax_full_mha__spectral_fnet__prompt_kernel_fm6a
    v_mfma_f32_32x32x16_bf16 v[44:59], v[112:115], v[100:103], v[44:59]
gated_mix__softmax_full_mha__spectral_fnet__prompt_kernel_fm6a:
    s_bitcmp1_b32 s30, 1
    s_cbranch_scc0 gated_mix__softmax_full_mha__spectral_fnet__prompt_kernel_fm6b
    v_mfma_f32_32x32x16_bf16 v[60:75], v[96:99], v[156:159], v[60:75]
gated_mix__softmax_full_mha__spectral_fnet__prompt_kernel_fm6b:
    s_bitcmp1_b32 s30, 2
    s_cbranch_scc0 gated_mix__softmax_full_mha__spectral_fnet__prompt_kernel_fm6c
    v_mfma_f32_32x32x16_bf16 v[60:75], v[112:115], v[156:159], v[60:75]
gated_mix__softmax_full_mha__spectral_fnet__prompt_kernel_fm6c:
    s_nop 4
    s_add_u32 s48, s61, 9216
    buffer_load_dwordx4 v[96:99], v2, s[32:35], s48 offen sc1
    s_add_u32 s48, s63, 288
    buffer_load_dwordx4 v[100:103], v7, s[36:39], s48 offen
    s_add_u32 s48, s60, 9216
    buffer_load_dwordx4 v[112:115], v2, s[32:35], s48 offen sc1
    s_add_u32 s48, s62, 9216
    buffer_load_dwordx4 v[104:107], v2, s[32:35], s48 offen sc1
    s_add_u32 s48, s63, 288
    buffer_load_dwordx4 v[108:111], v7, s[40:43], s48 offen
    s_waitcnt vmcnt(15)
    v_mfma_f32_32x32x16_bf16 v[12:27], v[116:119], v[120:123], v[12:27]
    v_mfma_f32_32x32x16_bf16 v[28:43], v[124:127], v[128:131], v[28:43]
    s_cmp_eq_u32 s30, 0
    s_cbranch_scc1 gated_mix__softmax_full_mha__spectral_fnet__prompt_kernel_fm7c
    s_bitcmp1_b32 s30, 0
    s_cbranch_scc0 gated_mix__softmax_full_mha__spectral_fnet__prompt_kernel_fm7a
    v_mfma_f32_32x32x16_bf16 v[44:59], v[132:135], v[120:123], v[44:59]
gated_mix__softmax_full_mha__spectral_fnet__prompt_kernel_fm7a:
    s_bitcmp1_b32 s30, 1
    s_cbranch_scc0 gated_mix__softmax_full_mha__spectral_fnet__prompt_kernel_fm7b
    v_mfma_f32_32x32x16_bf16 v[60:75], v[116:119], v[156:159], v[60:75]
gated_mix__softmax_full_mha__spectral_fnet__prompt_kernel_fm7b:
    s_bitcmp1_b32 s30, 2
    s_cbranch_scc0 gated_mix__softmax_full_mha__spectral_fnet__prompt_kernel_fm7c
    v_mfma_f32_32x32x16_bf16 v[60:75], v[132:135], v[156:159], v[60:75]
gated_mix__softmax_full_mha__spectral_fnet__prompt_kernel_fm7c:
    s_nop 4
    s_add_u32 s48, s61, 10240
    buffer_load_dwordx4 v[116:119], v2, s[32:35], s48 offen sc1
    s_add_u32 s48, s63, 320
    buffer_load_dwordx4 v[120:123], v7, s[36:39], s48 offen
    s_add_u32 s48, s60, 10240
    buffer_load_dwordx4 v[132:135], v2, s[32:35], s48 offen sc1
    s_add_u32 s48, s62, 10240
    buffer_load_dwordx4 v[124:127], v2, s[32:35], s48 offen sc1
    s_add_u32 s48, s63, 320
    buffer_load_dwordx4 v[128:131], v7, s[40:43], s48 offen
    s_waitcnt vmcnt(15)
    v_mfma_f32_32x32x16_bf16 v[12:27], v[136:139], v[140:143], v[12:27]
    v_mfma_f32_32x32x16_bf16 v[28:43], v[144:147], v[148:151], v[28:43]
    s_cmp_eq_u32 s30, 0
    s_cbranch_scc1 gated_mix__softmax_full_mha__spectral_fnet__prompt_kernel_fm8c
    s_bitcmp1_b32 s30, 0
    s_cbranch_scc0 gated_mix__softmax_full_mha__spectral_fnet__prompt_kernel_fm8a
    v_mfma_f32_32x32x16_bf16 v[44:59], v[152:155], v[140:143], v[44:59]
gated_mix__softmax_full_mha__spectral_fnet__prompt_kernel_fm8a:
    s_bitcmp1_b32 s30, 1
    s_cbranch_scc0 gated_mix__softmax_full_mha__spectral_fnet__prompt_kernel_fm8b
    v_mfma_f32_32x32x16_bf16 v[60:75], v[136:139], v[156:159], v[60:75]
gated_mix__softmax_full_mha__spectral_fnet__prompt_kernel_fm8b:
    s_bitcmp1_b32 s30, 2
    s_cbranch_scc0 gated_mix__softmax_full_mha__spectral_fnet__prompt_kernel_fm8c
    v_mfma_f32_32x32x16_bf16 v[60:75], v[152:155], v[156:159], v[60:75]
gated_mix__softmax_full_mha__spectral_fnet__prompt_kernel_fm8c:
    s_nop 4
    s_add_u32 s48, s61, 11264
    buffer_load_dwordx4 v[136:139], v2, s[32:35], s48 offen sc1
    s_add_u32 s48, s63, 352
    buffer_load_dwordx4 v[140:143], v7, s[36:39], s48 offen
    s_add_u32 s48, s60, 11264
    buffer_load_dwordx4 v[152:155], v2, s[32:35], s48 offen sc1
    s_add_u32 s48, s62, 11264
    buffer_load_dwordx4 v[144:147], v2, s[32:35], s48 offen sc1
    s_add_u32 s48, s63, 352
    buffer_load_dwordx4 v[148:151], v7, s[40:43], s48 offen
    s_waitcnt vmcnt(15)
    v_mfma_f32_32x32x16_bf16 v[12:27], v[76:79], v[80:83], v[12:27]
    v_mfma_f32_32x32x16_bf16 v[28:43], v[84:87], v[88:91], v[28:43]
    s_cmp_eq_u32 s30, 0
    s_cbranch_scc1 gated_mix__softmax_full_mha__spectral_fnet__prompt_kernel_fm9c
    s_bitcmp1_b32 s30, 0
    s_cbranch_scc0 gated_mix__softmax_full_mha__spectral_fnet__prompt_kernel_fm9a
    v_mfma_f32_32x32x16_bf16 v[44:59], v[92:95], v[80:83], v[44:59]
gated_mix__softmax_full_mha__spectral_fnet__prompt_kernel_fm9a:
    s_bitcmp1_b32 s30, 1
    s_cbranch_scc0 gated_mix__softmax_full_mha__spectral_fnet__prompt_kernel_fm9b
    v_mfma_f32_32x32x16_bf16 v[60:75], v[76:79], v[156:159], v[60:75]
gated_mix__softmax_full_mha__spectral_fnet__prompt_kernel_fm9b:
    s_bitcmp1_b32 s30, 2
    s_cbranch_scc0 gated_mix__softmax_full_mha__spectral_fnet__prompt_kernel_fm9c
    v_mfma_f32_32x32x16_bf16 v[60:75], v[92:95], v[156:159], v[60:75]
gated_mix__softmax_full_mha__spectral_fnet__prompt_kernel_fm9c:
    s_nop 4
    s_add_u32 s48, s61, 12288
    buffer_load_dwordx4 v[76:79], v2, s[32:35], s48 offen sc1
    s_add_u32 s48, s63, 384
    buffer_load_dwordx4 v[80:83], v7, s[36:39], s48 offen
    s_add_u32 s48, s60, 12288
    buffer_load_dwordx4 v[92:95], v2, s[32:35], s48 offen sc1
    s_add_u32 s48, s62, 12288
    buffer_load_dwordx4 v[84:87], v2, s[32:35], s48 offen sc1
    s_add_u32 s48, s63, 384
    buffer_load_dwordx4 v[88:91], v7, s[40:43], s48 offen
    s_waitcnt vmcnt(15)
    v_mfma_f32_32x32x16_bf16 v[12:27], v[96:99], v[100:103], v[12:27]
    v_mfma_f32_32x32x16_bf16 v[28:43], v[104:107], v[108:111], v[28:43]
    s_cmp_eq_u32 s30, 0
    s_cbranch_scc1 gated_mix__softmax_full_mha__spectral_fnet__prompt_kernel_fm10c
    s_bitcmp1_b32 s30, 0
    s_cbranch_scc0 gated_mix__softmax_full_mha__spectral_fnet__prompt_kernel_fm10a
    v_mfma_f32_32x32x16_bf16 v[44:59], v[112:115], v[100:103], v[44:59]
gated_mix__softmax_full_mha__spectral_fnet__prompt_kernel_fm10a:
    s_bitcmp1_b32 s30, 1
    s_cbranch_scc0 gated_mix__softmax_full_mha__spectral_fnet__prompt_kernel_fm10b
    v_mfma_f32_32x32x16_bf16 v[60:75], v[96:99], v[156:159], v[60:75]
gated_mix__softmax_full_mha__spectral_fnet__prompt_kernel_fm10b:
    s_bitcmp1_b32 s30, 2
    s_cbranch_scc0 gated_mix__softmax_full_mha__spectral_fnet__prompt_kernel_fm10c
    v_mfma_f32_32x32x16_bf16 v[60:75], v[112:115], v[156:159], v[60:75]
gated_mix__softmax_full_mha__spectral_fnet__prompt_kernel_fm10c:
    s_nop 4
    s_add_u32 s48, s61, 13312
    buffer_load_dwordx4 v[96:99], v2, s[32:35], s48 offen sc1
    s_add_u32 s48, s63, 416
    buffer_load_dwordx4 v[100:103], v7, s[36:39], s48 offen
    s_add_u32 s48, s60, 13312
    buffer_load_dwordx4 v[112:115], v2, s[32:35], s48 offen sc1
    s_add_u32 s48, s62, 13312
    buffer_load_dwordx4 v[104:107], v2, s[32:35], s48 offen sc1
    s_add_u32 s48, s63, 416
    buffer_load_dwordx4 v[108:111], v7, s[40:43], s48 offen
    s_waitcnt vmcnt(15)
    v_mfma_f32_32x32x16_bf16 v[12:27], v[116:119], v[120:123], v[12:27]
    v_mfma_f32_32x32x16_bf16 v[28:43], v[124:127], v[128:131], v[28:43]
    s_cmp_eq_u32 s30, 0
    s_cbranch_scc1 gated_mix__softmax_full_mha__spectral_fnet__prompt_kernel_fm11c
    s_bitcmp1_b32 s30, 0
    s_cbranch_scc0 gated_mix__softmax_full_mha__spectral_fnet__prompt_kernel_fm11a
    v_mfma_f32_32x32x16_bf16 v[44:59], v[132:135], v[120:123], v[44:59]
gated_mix__softmax_full_mha__spectral_fnet__prompt_kernel_fm11a:
    s_bitcmp1_b32 s30, 1
    s_cbranch_scc0 gated_mix__softmax_full_mha__spectral_fnet__prompt_kernel_fm11b
    v_mfma_f32_32x32x16_bf16 v[60:75], v[116:119], v[156:159], v[60:75]
gated_mix__softmax_full_mha__spectral_fnet__prompt_kernel_fm11b:
    s_bitcmp1_b32 s30, 2
    s_cbranch_scc0 gated_mix__softmax_full_mha__spectral_fnet__prompt_kernel_fm11c
    v_mfma_f32_32x32x16_bf16 v[60:75], v[132:135], v[156:159], v[60:75]
gated_mix__softmax_full_mha__spectral_fnet__prompt_kernel_fm11c:
    s_nop 4
    s_add_u32 s48, s61, 14336
    buffer_load_dwordx4 v[116:119], v2, s[32:35], s48 offen sc1
    s_add_u32 s48, s63, 448
    buffer_load_dwordx4 v[120:123], v7, s[36:39], s48 offen
    s_add_u32 s48, s60, 14336
    buffer_load_dwordx4 v[132:135], v2, s[32:35], s48 offen sc1
    s_add_u32 s48, s62, 14336
    buffer_load_dwordx4 v[124:127], v2, s[32:35], s48 offen sc1
    s_add_u32 s48, s63, 448
    buffer_load_dwordx4 v[128:131], v7, s[40:43], s48 offen
    s_waitcnt vmcnt(15)
    v_mfma_f32_32x32x16_bf16 v[12:27], v[136:139], v[140:143], v[12:27]
    v_mfma_f32_32x32x16_bf16 v[28:43], v[144:147], v[148:151], v[28:43]
    s_cmp_eq_u32 s30, 0
    s_cbranch_scc1 gated_mix__softmax_full_mha__spectral_fnet__prompt_kernel_fm12c
    s_bitcmp1_b32 s30, 0
    s_cbranch_scc0 gated_mix__softmax_full_mha__spectral_fnet__prompt_kernel_fm12a
    v_mfma_f32_32x32x16_bf16 v[44:59], v[152:155], v[140:143], v[44:59]
gated_mix__softmax_full_mha__spectral_fnet__prompt_kernel_fm12a:
    s_bitcmp1_b32 s30, 1
    s_cbranch_scc0 gated_mix__softmax_full_mha__spectral_fnet__prompt_kernel_fm12b
    v_mfma_f32_32x32x16_bf16 v[60:75], v[136:139], v[156:159], v[60:75]
gated_mix__softmax_full_mha__spectral_fnet__prompt_kernel_fm12b:
    s_bitcmp1_b32 s30, 2
    s_cbranch_scc0 gated_mix__softmax_full_mha__spectral_fnet__prompt_kernel_fm12c
    v_mfma_f32_32x32x16_bf16 v[60:75], v[152:155], v[156:159], v[60:75]
gated_mix__softmax_full_mha__spectral_fnet__prompt_kernel_fm12c:
    s_nop 4
    s_add_u32 s48, s61, 15360
    buffer_load_dwordx4 v[136:139], v2, s[32:35], s48 offen sc1
    s_add_u32 s48, s63, 480
    buffer_load_dwordx4 v[140:143], v7, s[36:39], s48 offen
    s_add_u32 s48, s60, 15360
    buffer_load_dwordx4 v[152:155], v2, s[32:35], s48 offen sc1
    s_add_u32 s48, s62, 15360
    buffer_load_dwordx4 v[144:147], v2, s[32:35], s48 offen sc1
    s_add_u32 s48, s63, 480
    buffer_load_dwordx4 v[148:151], v7, s[40:43], s48 offen
    s_waitcnt vmcnt(15)
    v_mfma_f32_32x32x16_bf16 v[12:27], v[76:79], v[80:83], v[12:27]
    v_mfma_f32_32x32x16_bf16 v[28:43], v[84:87], v[88:91], v[28:43]
    s_cmp_eq_u32 s30, 0
    s_cbranch_scc1 gated_mix__softmax_full_mha__spectral_fnet__prompt_kernel_fm13c
    s_bitcmp1_b32 s30, 0
    s_cbranch_scc0 gated_mix__softmax_full_mha__spectral_fnet__prompt_kernel_fm13a
    v_mfma_f32_32x32x16_bf16 v[44:59], v[92:95], v[80:83], v[44:59]
gated_mix__softmax_full_mha__spectral_fnet__prompt_kernel_fm13a:
    s_bitcmp1_b32 s30, 1
    s_cbranch_scc0 gated_mix__softmax_full_mha__spectral_fnet__prompt_kernel_fm13b
    v_mfma_f32_32x32x16_bf16 v[60:75], v[76:79], v[156:159], v[60:75]
gated_mix__softmax_full_mha__spectral_fnet__prompt_kernel_fm13b:
    s_bitcmp1_b32 s30, 2
    s_cbranch_scc0 gated_mix__softmax_full_mha__spectral_fnet__prompt_kernel_fm13c
    v_mfma_f32_32x32x16_bf16 v[60:75], v[92:95], v[156:159], v[60:75]
gated_mix__softmax_full_mha__spectral_fnet__prompt_kernel_fm13c:
    s_waitcnt vmcnt(10)
    v_mfma_f32_32x32x16_bf16 v[12:27], v[96:99], v[100:103], v[12:27]
    v_mfma_f32_32x32x16_bf16 v[28:43], v[104:107], v[108:111], v[28:43]
    s_cmp_eq_u32 s30, 0
    s_cbranch_scc1 gated_mix__softmax_full_mha__spectral_fnet__prompt_kernel_fm14c
    s_bitcmp1_b32 s30, 0
    s_cbranch_scc0 gated_mix__softmax_full_mha__spectral_fnet__prompt_kernel_fm14a
    v_mfma_f32_32x32x16_bf16 v[44:59], v[112:115], v[100:103], v[44:59]
gated_mix__softmax_full_mha__spectral_fnet__prompt_kernel_fm14a:
    s_bitcmp1_b32 s30, 1
    s_cbranch_scc0 gated_mix__softmax_full_mha__spectral_fnet__prompt_kernel_fm14b
    v_mfma_f32_32x32x16_bf16 v[60:75], v[96:99], v[156:159], v[60:75]
gated_mix__softmax_full_mha__spectral_fnet__prompt_kernel_fm14b:
    s_bitcmp1_b32 s30, 2
    s_cbranch_scc0 gated_mix__softmax_full_mha__spectral_fnet__prompt_kernel_fm14c
    v_mfma_f32_32x32x16_bf16 v[60:75], v[112:115], v[156:159], v[60:75]
gated_mix__softmax_full_mha__spectral_fnet__prompt_kernel_fm14c:
    s_waitcnt vmcnt(5)
    v_mfma_f32_32x32x16_bf16 v[12:27], v[116:119], v[120:123], v[12:27]
    v_mfma_f32_32x32x16_bf16 v[28:43], v[124:127], v[128:131], v[28:43]
    s_cmp_eq_u32 s30, 0
    s_cbranch_scc1 gated_mix__softmax_full_mha__spectral_fnet__prompt_kernel_fm15c
    s_bitcmp1_b32 s30, 0
    s_cbranch_scc0 gated_mix__softmax_full_mha__spectral_fnet__prompt_kernel_fm15a
    v_mfma_f32_32x32x16_bf16 v[44:59], v[132:135], v[120:123], v[44:59]
gated_mix__softmax_full_mha__spectral_fnet__prompt_kernel_fm15a:
    s_bitcmp1_b32 s30, 1
    s_cbranch_scc0 gated_mix__softmax_full_mha__spectral_fnet__prompt_kernel_fm15b
    v_mfma_f32_32x32x16_bf16 v[60:75], v[116:119], v[156:159], v[60:75]
gated_mix__softmax_full_mha__spectral_fnet__prompt_kernel_fm15b:
    s_bitcmp1_b32 s30, 2
    s_cbranch_scc0 gated_mix__softmax_full_mha__spectral_fnet__prompt_kernel_fm15c
    v_mfma_f32_32x32x16_bf16 v[60:75], v[132:135], v[156:159], v[60:75]
gated_mix__softmax_full_mha__spectral_fnet__prompt_kernel_fm15c:
    s_waitcnt vmcnt(0)
    v_mfma_f32_32x32x16_bf16 v[12:27], v[136:139], v[140:143], v[12:27]
    v_mfma_f32_32x32x16_bf16 v[28:43], v[144:147], v[148:151], v[28:43]
    s_cmp_eq_u32 s30, 0
    s_cbranch_scc1 gated_mix__softmax_full_mha__spectral_fnet__prompt_kernel_fm16c
    s_bitcmp1_b32 s30, 0
    s_cbranch_scc0 gated_mix__softmax_full_mha__spectral_fnet__prompt_kernel_fm16a
    v_mfma_f32_32x32x16_bf16 v[44:59], v[152:155], v[140:143], v[44:59]
gated_mix__softmax_full_mha__spectral_fnet__prompt_kernel_fm16a:
    s_bitcmp1_b32 s30, 1
    s_cbranch_scc0 gated_mix__softmax_full_mha__spectral_fnet__prompt_kernel_fm16b
    v_mfma_f32_32x32x16_bf16 v[60:75], v[136:139], v[156:159], v[60:75]
gated_mix__softmax_full_mha__spectral_fnet__prompt_kernel_fm16b:
    s_bitcmp1_b32 s30, 2
    s_cbranch_scc0 gated_mix__softmax_full_mha__spectral_fnet__prompt_kernel_fm16c
    v_mfma_f32_32x32x16_bf16 v[60:75], v[152:155], v[156:159], v[60:75]
gated_mix__softmax_full_mha__spectral_fnet__prompt_kernel_fm16c:
gated_mix__softmax_full_mha__spectral_fnet__prompt_kernel_f2x:
    s_cmp_lg_u32 s54, 0
    s_cbranch_scc1 gated_mix__softmax_full_mha__spectral_fnet__prompt_kernel_fnox
    s_nop 4
    s_add_u32 s48, s61, 65536
    buffer_load_dwordx4 v[76:79], v2, s[32:35], s48 offen sc1
    s_add_u32 s48, s63, 2048
    buffer_load_dwordx4 v[80:83], v7, s[36:39], s48 offen
    s_add_u32 s48, s60, 65536
    buffer_load_dwordx4 v[92:95], v2, s[32:35], s48 offen sc1
    s_waitcnt vmcnt(0)
    v_mfma_f32_32x32x16_bf16 v[12:27], v[76:79], v[80:83], v[12:27]
    s_cmp_eq_u32 s30, 0
    s_cbranch_scc1 gated_mix__softmax_full_mha__spectral_fnet__prompt_kernel_fm17c
    s_bitcmp1_b32 s30, 0
    s_cbranch_scc0 gated_mix__softmax_full_mha__spectral_fnet__prompt_kernel_fm17a
    v_mfma_f32_32x32x16_bf16 v[44:59], v[92:95], v[80:83], v[44:59]
gated_mix__softmax_full_mha__spectral_fnet__prompt_kernel_fm17a:
    s_bitcmp1_b32 s30, 1
    s_cbranch_scc0 gated_mix__softmax_full_mha__spectral_fnet__prompt_kernel_fm17b
    v_mfma_f32_32x32x16_bf16 v[60:75], v[76:79], v[156:159], v[60:75]
gated_mix__softmax_full_mha__spectral_fnet__prompt_kernel_fm17b:
    s_bitcmp1_b32 s30, 2
    s_cbranch_scc0 gated_mix__softmax_full_mha__spectral_fnet__prompt_kernel_fm17c
    v_mfma_f32_32x32x16_bf16 v[60:75], v[92:95], v[156:159], v[60:75]
gated_mix__softmax_full_mha__spectral_fnet__prompt_kernel_fm17c:
gated_mix__softmax_full_mha__spectral_fnet__prompt_kernel_fnox:
    s_nop 15
    s_nop 3
    s_cmp_eq_u32 s54, 0
    s_cbranch_scc1 gated_mix__softmax_full_mha__spectral_fnet__prompt_kernel_rw0
    s_cmp_lt_u32 s54, 0
    s_cselect_b32 s48, 0, 1
    s_sub_u32 s48, s54, s48
    s_add_u32 s48, s48, 0
    s_lshl_b32 s48, s48, 11
    s_add_u32 s48, s48, 135424
    v_add_u32 v3, s48, v2
    ds_write_b128 v3, v[12:15]
    ds_write_b128 v3, v[28:31] offset:1024
gated_mix__softmax_full_mha__spectral_fnet__prompt_kernel_rw0:
    s_cmp_eq_u32 s54, 1
    s_cbranch_scc1 gated_mix__softmax_full_mha__spectral_fnet__prompt_kernel_rw1
    s_cmp_lt_u32 s54, 1
    s_cselect_b32 s48, 0, 1
    s_sub_u32 s48, s54, s48
    s_add_u32 s48, s48, 3
    s_lshl_b32 s48, s48, 11
    s_add_u32 s48, s48, 135424
    v_add_u32 v3, s48, v2
    ds_write_b128 v3, v[16:19]
    ds_write_b128 v3, v[32:35] offset:1024
gated_mix__softmax_full_mha__spectral_fnet__prompt_kernel_rw1:
    s_cmp_eq_u32 s54, 2
    s_cbranch_scc1 gated_mix__softmax_full_mha__spectral_fnet__prompt_kernel_rw2
    s_cmp_lt_u32 s54, 2
    s_cselect_b32 s48, 0, 1
    s_sub_u32 s48, s54, s48
    s_add_u32 s48, s48, 6
    s_lshl_b32 s48, s48, 11
    s_add_u32 s48, s48, 135424
    v_add_u32 v3, s48, v2
    ds_write_b128 v3, v[20:23]
    ds_write_b128 v3, v[36:39] offset:1024
gated_mix__softmax_full_mha__spectral_fnet__prompt_kernel_rw2:
    s_cmp_eq_u32 s54, 3
    s_cbranch_scc1 gated_mix__softmax_full_mha__spectral_fnet__prompt_kernel_rw3
    s_cmp_lt_u32 s54, 3
    s_cselect_b32 s48, 0, 1
    s_sub_u32 s48, s54, s48
    s_add_u32 s48, s48, 9
    s_lshl_b32 s48, s48, 11
    s_add_u32 s48, s48, 135424
    v_add_u32 v3, s48, v2
    ds_write_b128 v3, v[24:27]
    ds_write_b128 v3, v[40:43] offset:1024
gated_mix__softmax_full_mha__spectral_fnet__prompt_kernel_rw3:
    s_cmp_eq_u32 s30, 0
    s_cbranch_scc1 gated_mix__softmax_full_mha__spectral_fnet__prompt_kernel_rwx
    s_cmp_eq_u32 s54, 0
    s_cbranch_scc1 gated_mix__softmax_full_mha__spectral_fnet__prompt_kernel_rwx
    s_sub_u32 s48, s54, 1
    s_lshl_b32 s48, s48, 9
    s_add_u32 s48, s48, 160000
    v_lshrrev_b32 v4, 2, v2
    v_add_u32 v4, s48, v4
    ds_write_b32 v4, v44
    v_lshrrev_b32 v4, 5, v1
    v_lshlrev_b32 v4, 6, v4
    v_add_u32 v4, s48, v4
    s_mov_b32 exec_lo, 1
    s_mov_b32 exec_hi, 1
    ds_write_b128 v4, v[60:63] offset:256
    ds_write_b128 v4, v[64:67] offset:272
    ds_write_b128 v4, v[68:71] offset:288
    ds_write_b128 v4, v[72:75] offset:304
    s_mov_b64 exec, -1
gated_mix__softmax_full_mha__spectral_fnet__prompt_kernel_rwx:
    s_waitcnt lgkmcnt(0)
    v_mov_b32 v3, 135188
    v_mov_b32 v4, 1
    s_mov_b64 exec, 1
    ds_add_u32 v3, v4
    s_mov_b64 exec, -1
    v_mov_b32 v3, 135188
    s_mov_b32 s51, 1048576
gated_mix__softmax_full_mha__spectral_fnet__prompt_kernel_fw0:
    ds_read_b32 v4, v3
    s_waitcnt lgkmcnt(0)
    v_readfirstlane_b32 s48, v4
    s_sub_u32 s51, s51, 1
    s_cbranch_scc1 gated_mix__softmax_full_mha__spectral_fnet__prompt_kernel_fw0_ok
    s_nop 1
    s_cmp_ge_u32 s48, 4
    s_cbranch_scc1 gated_mix__softmax_full_mha__spectral_fnet__prompt_kernel_fw0_ok
    s_sleep 4
    s_branch gated_mix__softmax_full_mha__spectral_fnet__prompt_kernel_fw0
gated_mix__softmax_full_mha__spectral_fnet__prompt_kernel_fw0_ok:
    s_mul_i32 s48, s54, 6144
    s_add_u32 s48, s48, 135424
    v_add_u32 v3, s48, v2
    ds_read_b128 v[76:79], v3 offset:0
    ds_read_b128 v[80:83], v3 offset:1024
    ds_read_b128 v[84:87], v3 offset:2048
    ds_read_b128 v[88:91], v3 offset:3072
    ds_read_b128 v[92:95], v3 offset:4096
    ds_read_b128 v[96:99], v3 offset:5120
    s_lshl_b32 s50, s59, 7
    s_lshl_b32 s49, s54, 5
    s_add_u32 s50, s50, s49
    s_waitcnt lgkmcnt(0)
    s_cmp_lg_u32 s54, 0
    s_cbranch_scc1 gated_mix__softmax_full_mha__spectral_fnet__prompt_kernel_rr0
    v_add_f32 v76, v76, v12
    v_add_f32 v80, v80, v28
    v_add_f32 v77, v77, v13
    v_add_f32 v81, v81, v29
    v_add_f32 v78, v78, v14
    v_add_f32 v82, v82, v30
    v_add_f32 v79, v79, v15
    v_add_f32 v83, v83, v31
gated_mix__softmax_full_mha__spectral_fnet__prompt_kernel_rr0:
    s_cmp_lg_u32 s54, 1
    s_cbranch_scc1 gated_mix__softmax_full_mha__spectral_fnet__prompt_kernel_rr1
    v_add_f32 v76, v76, v16
    v_add_f32 v80, v80, v32
    v_add_f32 v77, v77, v17
    v_add_f32 v81, v81, v33
    v_add_f32 v78, v78, v18
    v_add_f32 v82, v82, v34
    v_add_f32 v79, v79, v19
    v_add_f32 v83, v83, v35
gated_mix__softmax_full_mha__spectral_fnet__prompt_kernel_rr1:
    s_cmp_lg_u32 s54, 2
    s_cbranch_scc1 gated_mix__softmax_full_mha__spectral_fnet__prompt_kernel_rr2
    v_add_f32 v76, v76, v20
    v_add_f32 v80, v80, v36
    v_add_f32 v77, v77, v21
    v_add_f32 v81, v81, v37
    v_add_f32 v78, v78, v22
    v_add_f32 v82, v82, v38
    v_add_f32 v79, v79, v23
    v_add_f32 v83, v83, v39
gated_mix__softmax_full_mha__spectral_fnet__prompt_kernel_rr2:
    s_cmp_lg_u32 s54, 3
    s_cbranch_scc1 gated_mix__softmax_full_mha__spectral_fnet__prompt_kernel_rr3
    v_add_f32 v76, v76, v24
    v_add_f32 v80, v80, v40
    v_add_f32 v77, v77, v25
    v_add_f32 v81, v81, v41
    v_add_f32 v78, v78, v26
    v_add_f32 v82, v82, v42
    v_add_f32 v79, v79, v27
    v_add_f32 v83, v83, v43
gated_mix__softmax_full_mha__spectral_fnet__prompt_kernel_rr3:
    v_add_f32 v76, v76, v84
    v_add_f32 v77, v77, v85
    v_add_f32 v78, v78, v86
    v_add_f32 v79, v79, v87
    v_add_f32 v80, v80, v88
    v_add_f32 v81, v81, v89
    v_add_f32 v82, v82, v90
    v_add_f32 v83, v83, v91
    v_add_f32 v76, v76, v92
    v_add_f32 v77, v77, v93
    v_add_f32 v78, v78, v94
    v_add_f32 v79, v79, v95
    v_add_f32 v80, v80, v96
    v_add_f32 v81, v81, v97
    v_add_f32 v82, v82, v98
    v_add_f32 v83, v83, v99
    v_sub_f32 v84, v76, v80
    v_add_f32 v88, v76, v80
    v_sub_f32 v85, v77, v81
    v_add_f32 v89, v77, v81
    v_sub_f32 v86, v78, v82
    v_add_f32 v90, v78, v82
    v_sub_f32 v87, v79, v83
    v_add_f32 v91, v79, v83
    s_add_u32 s49, s50, 10485760
    buffer_store_dwordx4 v[84:87], v8, s[32:35], s49 offen sc1
    s_add_u32 s49, s50, 12582912
    buffer_store_dwordx4 v[88:91], v8, s[32:35], s49 offen sc1
    s_cmp_eq_u32 s30, 0
    s_cbranch_scc1 gated_mix__softmax_full_mha__spectral_fnet__prompt_kernel_fo3
    s_cmp_lg_u32 s54, 0
    s_cbranch_scc1 gated_mix__softmax_full_mha__spectral_fnet__prompt_kernel_fo3
    v_lshrrev_b32 v5, 2, v2
    v_add_u32 v5, 160000, v5
    v_lshrrev_b32 v4, 5, v1
    v_lshlrev_b32 v4, 6, v4
    v_add_u32 v4, 160000, v4
    ds_read_b32 v108, v5 offset:0
    ds_read_b128 v[112:115], v4 offset:256
    ds_read_b128 v[116:119], v4 offset:272
    ds_read_b128 v[120:123], v4 offset:288
    ds_read_b128 v[124:127], v4 offset:304
    s_waitcnt lgkmcnt(0)
    v_add_f32 v44, v44, v108
    v_add_f32 v60, v60, v112
    v_add_f32 v61, v61, v113
    v_add_f32 v62, v62, v114
    v_add_f32 v63, v63, v115
    v_add_f32 v64, v64, v116
    v_add_f32 v65, v65, v117
    v_add_f32 v66, v66, v118
    v_add_f32 v67, v67, v119
    v_add_f32 v68, v68, v120
    v_add_f32 v69, v69, v121
    v_add_f32 v70, v70, v122
    v_add_f32 v71, v71, v123
    v_add_f32 v72, v72, v124
    v_add_f32 v73, v73, v125
    v_add_f32 v74, v74, v126
    v_add_f32 v75, v75, v127
    ds_read_b32 v108, v5 offset:512
    ds_read_b128 v[112:115], v4 offset:768
    ds_read_b128 v[116:119], v4 offset:784
    ds_read_b128 v[120:123], v4 offset:800
    ds_read_b128 v[124:127], v4 offset:816
    s_waitcnt lgkmcnt(0)
    v_add_f32 v44, v44, v108
    v_add_f32 v60, v60, v112
    v_add_f32 v61, v61, v113
    v_add_f32 v62, v62, v114
    v_add_f32 v63, v63, v115
    v_add_f32 v64, v64, v116
    v_add_f32 v65, v65, v117
    v_add_f32 v66, v66, v118
    v_add_f32 v67, v67, v119
    v_add_f32 v68, v68, v120
    v_add_f32 v69, v69, v121
    v_add_f32 v70, v70, v122
    v_add_f32 v71, v71, v123
    v_add_f32 v72, v72, v124
    v_add_f32 v73, v73, v125
    v_add_f32 v74, v74, v126
    v_add_f32 v75, v75, v127
    ds_read_b32 v108, v5 offset:1024
    ds_read_b128 v[112:115], v4 offset:1280
    ds_read_b128 v[116:119], v4 offset:1296
    ds_read_b128 v[120:123], v4 offset:1312
    ds_read_b128 v[124:127], v4 offset:1328
    s_waitcnt lgkmcnt(0)
    v_add_f32 v44, v44, v108
    v_add_f32 v60, v60, v112
    v_add_f32 v61, v61, v113
    v_add_f32 v62, v62, v114
    v_add_f32 v63, v63, v115
    v_add_f32 v64, v64, v116
    v_add_f32 v65, v65, v117
    v_add_f32 v66, v66, v118
    v_add_f32 v67, v67, v119
    v_add_f32 v68, v68, v120
    v_add_f32 v69, v69, v121
    v_add_f32 v70, v70, v122
    v_add_f32 v71, v71, v123
    v_add_f32 v72, v72, v124
    v_add_f32 v73, v73, v125
    v_add_f32 v74, v74, v126
    v_add_f32 v75, v75, v127
    s_lshl_b32 s48, s59, 7
    s_bitcmp1_b32 s30, 0
    s_cbranch_scc0 gated_mix__softmax_full_mha__spectral_fnet__prompt_kernel_fo1
    s_mov_b32 exec_hi, 0
    s_mov_b32 s50, 10486784
    buffer_store_dword v44, v8, s[32:35], s50 offen sc1
    s_mov_b32 s50, 12583936
    buffer_store_dword v44, v8, s[32:35], s50 offen sc1
    s_mov_b64 exec, -1
gated_mix__softmax_full_mha__spectral_fnet__prompt_kernel_fo1:
    s_bitcmp1_b32 s30, 1
    s_cbranch_scc0 gated_mix__softmax_full_mha__spectral_fnet__prompt_kernel_fo2
    v_lshrrev_b32 v4, 5, v1
    v_lshlrev_b32 v4, 4, v4
    s_mov_b32 exec_lo, 1
    s_mov_b32 exec_hi, 1
    s_add_u32 s50, s48, 11665408
    buffer_store_dwordx4 v[60:63], v4, s[32:35], s50 offen sc1
    s_add_u32 s50, s48, 13762560
    buffer_store_dwordx4 v[60:63], v4, s[32:35], s50 offen sc1
    s_add_u32 s50, s48, 11665440
    buffer_store_dwordx4 v[64:67], v4, s[32:35], s50 offen sc1
    s_add_u32 s50, s48, 13762592
    buffer_store_dwordx4 v[64:67], v4, s[32:35], s50 offen sc1
    s_add_u32 s50, s48, 11665472
    buffer_store_dwordx4 v[68:71], v4, s[32:35], s50 offen sc1
    s_add_u32 s50, s48, 13762624
    buffer_store_dwordx4 v[68:71], v4, s[32:35], s50 offen sc1
    s_add_u32 s50, s48, 11665504
    buffer_store_dwordx4 v[72:75], v4, s[32:35], s50 offen sc1
    s_add_u32 s50, s48, 13762656
    buffer_store_dwordx4 v[72:75], v4, s[32:35], s50 offen sc1
    s_mov_b64 exec, -1
gated_mix__softmax_full_mha__spectral_fnet__prompt_kernel_fo2:
    s_bitcmp1_b32 s30, 2
    s_cbranch_scc0 gated_mix__softmax_full_mha__spectral_fnet__prompt_kernel_fo3
    v_mov_b32 v4, 0
    s_mov_b64 exec, 1
    s_mov_b32 s50, 11666432
    buffer_store_dword v60, v4, s[32:35], s50 offen sc1
    s_mov_b32 s50, 13763584
    buffer_store_dword v60, v4, s[32:35], s50 offen sc1
    s_mov_b64 exec, -1
gated_mix__softmax_full_mha__spectral_fnet__prompt_kernel_fo3:
    v_mov_b32 v3, 135192
    v_mov_b32 v4, 1
    s_mov_b64 exec, 1
    ds_add_u32 v3, v4
    s_mov_b64 exec, -1
    s_waitcnt vmcnt(0)
    v_mov_b32 v3, 135268
    v_mov_b32 v4, 1
    s_mov_b64 exec, 1
    ds_add_rtn_u32 v5, v3, v4
    s_waitcnt lgkmcnt(0)
    s_mov_b64 exec, -1
    v_readfirstlane_b32 s48, v5
    s_nop 3
    s_cmp_lg_u32 s48, 3
    s_cbranch_scc1 gated_mix__softmax_full_mha__spectral_fnet__prompt_kernel_fsig
    s_add_u32 s48, s2, 768
    s_lshl_b32 s51, s48, 5
    s_add_u32 s51, s51, 14745600
    v_mov_b32 v3, s51
    v_mov_b32 v4, s29
    s_mov_b64 exec, 1
    global_store_dword v3, v4, s[26:27] sc1
    s_mov_b64 exec, -1
gated_mix__softmax_full_mha__spectral_fnet__prompt_kernel_fsig:
    s_setprio 3
    s_mov_b32 s56, s52
    s_mov_b32 s57, s53
    s_and_b32 s58, s54, 1
    s_lshr_b32 s59, s54, 1
    s_lshl_b32 s48, s58, 5
    s_lshl_b32 s60, s56, 6
    s_add_u32 s60, s60, s48
    s_lshl_b32 s48, s59, 5
    s_lshl_b32 s61, s57, 6
    s_add_u32 s61, s61, s48
    s_mov_b32 s36, s22
    s_and_b32 s37, s23, 0xffff
    s_mov_b32 s38, 2097152
    s_mov_b32 s39, 0x00020000
    s_mov_b32 s63, s10
    s_mov_b32 s62, s11
    s_lshl_b32 s48, s59, 8
    s_lshl_b32 s49, s58, 7
    s_add_u32 s48, s48, s49
    s_lshl_b32 s30, s48, 7
    s_lshl_b32 s48, s48, 10
    s_lshl_b32 s49, s57, 7
    s_add_u32 s50, s48, s49
    s_add_u32 s49, s50, 0
    buffer_load_dwordx4 v[32:35], v164, s[44:47], s49 offen
    s_add_u32 s49, s50, 8192
    buffer_load_dwordx4 v[36:39], v164, s[44:47], s49 offen
    s_add_u32 s49, s50, 16384
    buffer_load_dwordx4 v[40:43], v164, s[44:47], s49 offen
    s_add_u32 s49, s50, 24576
    buffer_load_dwordx4 v[44:47], v164, s[44:47], s49 offen
    s_add_u32 s49, s50, 32768
    buffer_load_dwordx4 v[48:51], v164, s[44:47], s49 offen
    s_add_u32 s49, s50, 40960
    buffer_load_dwordx4 v[52:55], v164, s[44:47], s49 offen
    s_add_u32 s49, s50, 49152
    buffer_load_dwordx4 v[56:59], v164, s[44:47], s49 offen
    s_add_u32 s49, s50, 57344
    buffer_load_dwordx4 v[60:63], v164, s[44:47], s49 offen
    s_add_u32 s49, s50, 65536
    buffer_load_dwordx4 v[64:67], v164, s[44:47], s49 offen
    s_add_u32 s49, s50, 73728
    buffer_load_dwordx4 v[68:71], v164, s[44:47], s49 offen
    s_add_u32 s49, s50, 81920
    buffer_load_dwordx4 v[72:75], v164, s[44:47], s49 offen
    s_add_u32 s49, s50, 90112
    buffer_load_dwordx4 v[76:79], v164, s[44:47], s49 offen
    s_add_u32 s49, s50, 98304
    buffer_load_dwordx4 v[80:83], v164, s[44:47], s49 offen
    s_add_u32 s49, s50, 106496
    buffer_load_dwordx4 v[84:87], v164, s[44:47], s49 offen
    s_add_u32 s49, s50, 114688
    buffer_load_dwordx4 v[88:91], v164, s[44:47], s49 offen
    s_add_u32 s49, s50, 122880
    buffer_load_dwordx4 v[92:95], v164, s[44:47], s49 offen
    s_cmp_lg_u32 s54, 0
    s_cbranch_scc1 gated_mix__softmax_full_mha__spectral_fnet__prompt_kernel_c1
    v_lshlrev_b32 v12, 5, v1
    v_add_u32 v12, 14770176, v12
    s_mov_b32 s31, 65536
gated_mix__softmax_full_mha__spectral_fnet__prompt_kernel_gd:
    global_load_dword v16, v12, s[26:27] offset:0 sc1
    global_load_dword v17, v12, s[26:27] offset:2048 sc1
    v_add_u32 v20, 4096, v12
    global_load_dword v18, v20, s[26:27] sc1
    v_add_u32 v20, 6144, v12
    global_load_dword v19, v20, s[26:27] sc1
    s_waitcnt vmcnt(0)
    v_cmp_ne_u32 vcc, s29, v16
    v_cmp_ne_u32 s[48:49], s29, v17
    s_nop 1
    s_or_b64 vcc, vcc, s[48:49]
    v_cmp_ne_u32 s[48:49], s29, v18
    s_nop 1
    s_or_b64 vcc, vcc, s[48:49]
    v_cmp_ne_u32 s[48:49], s29, v19
    s_nop 1
    s_or_b64 vcc, vcc, s[48:49]
    s_sub_u32 s31, s31, 1
    s_cbranch_scc1 gated_mix__softmax_full_mha__spectral_fnet__prompt_kernel_gd_ok
    s_nop 2
    s_cbranch_vccz gated_mix__softmax_full_mha__spectral_fnet__prompt_kernel_gd_ok
    s_sleep 8
    s_branch gated_mix__softmax_full_mha__spectral_fnet__prompt_kernel_gd
gated_mix__softmax_full_mha__spectral_fnet__prompt_kernel_gd_ok:
    v_mov_b32 v3, 135204
    v_mov_b32 v4, 1
    s_mov_b64 exec, 1
    ds_add_u32 v3, v4
    s_mov_b64 exec, -1
    s_branch gated_mix__softmax_full_mha__spectral_fnet__prompt_kernel_c2
gated_mix__softmax_full_mha__spectral_fnet__prompt_kernel_c1:
    v_mov_b32 v3, 135204
    s_mov_b32 s51, 1048576
gated_mix__softmax_full_mha__spectral_fnet__prompt_kernel_cw1:
    ds_read_b32 v4, v3
    s_waitcnt lgkmcnt(0)
    v_readfirstlane_b32 s48, v4
    s_sub_u32 s51, s51, 1
    s_cbranch_scc1 gated_mix__softmax_full_mha__spectral_fnet__prompt_kernel_cw1_ok
    s_nop 1
    s_cmp_ge_u32 s48, 1
    s_cbranch_scc1 gated_mix__softmax_full_mha__spectral_fnet__prompt_kernel_cw1_ok
    s_sleep 24
    s_branch gated_mix__softmax_full_mha__spectral_fnet__prompt_kernel_cw1
gated_mix__softmax_full_mha__spectral_fnet__prompt_kernel_cw1_ok:
gated_mix__softmax_full_mha__spectral_fnet__prompt_kernel_c2:
    s_mov_b32 s49, 14680064
    buffer_load_dword v9, v162, s[32:35], s49 offen sc1
    buffer_load_dwordx4 v[16:19], v163, s[32:35], s63 offen offset:0 sc1
    buffer_load_dwordx4 v[20:23], v163, s[32:35], s63 offen offset:32 sc1
    buffer_load_dwordx4 v[24:27], v163, s[32:35], s63 offen offset:64 sc1
    buffer_load_dwordx4 v[28:31], v163, s[32:35], s63 offen offset:96 sc1
    v_add_u32 v164, s30, v2
    s_lshl_b32 s48, s56, 1
    s_add_u32 s48, s48, s58
    s_lshl_b32 s48, s48, 5
    s_lshl_b32 s49, s59, 4
    s_add_u32 s48, s48, s49
    s_lshl_b32 s48, s48, 10
    s_add_u32 s30, s48, 6291456
    s_waitcnt vmcnt(0)
    s_setprio 0
    v_mov_b32 v3, 135264
    s_mov_b32 s51, 1048576
gated_mix__softmax_full_mha__spectral_fnet__prompt_kernel_cwn:
    ds_read_b32 v4, v3
    s_waitcnt lgkmcnt(0)
    v_readfirstlane_b32 s48, v4
    s_sub_u32 s51, s51, 1
    s_cbranch_scc1 gated_mix__softmax_full_mha__spectral_fnet__prompt_kernel_cwn_ok
    s_nop 1
    s_cmp_ge_u32 s48, 8
    s_cbranch_scc1 gated_mix__softmax_full_mha__spectral_fnet__prompt_kernel_cwn_ok
    s_sleep 24
    s_branch gated_mix__softmax_full_mha__spectral_fnet__prompt_kernel_cwn
gated_mix__softmax_full_mha__spectral_fnet__prompt_kernel_cwn_ok:
    s_setprio 3
    v_mov_b32 v3, 135200
    s_mov_b32 s51, 1048576
gated_mix__softmax_full_mha__spectral_fnet__prompt_kernel_cw2:
    ds_read_b32 v4, v3
    s_waitcnt lgkmcnt(0)
    v_readfirstlane_b32 s48, v4
    s_sub_u32 s51, s51, 1
    s_cbranch_scc1 gated_mix__softmax_full_mha__spectral_fnet__prompt_kernel_cw2_ok
    s_nop 1
    s_cmp_ge_u32 s48, 8
    s_cbranch_scc1 gated_mix__softmax_full_mha__spectral_fnet__prompt_kernel_cw2_ok
    s_sleep 3
    s_branch gated_mix__softmax_full_mha__spectral_fnet__prompt_kernel_cw2
gated_mix__softmax_full_mha__spectral_fnet__prompt_kernel_cw2_ok:
    ds_write_b128 v164, v[32:35] offset:0
    ds_write_b128 v164, v[36:39] offset:1024
    ds_write_b128 v164, v[40:43] offset:2048
    ds_write_b128 v164, v[44:47] offset:3072
    ds_write_b128 v164, v[48:51] offset:4096
    ds_write_b128 v164, v[52:55] offset:5120
    ds_write_b128 v164, v[56:59] offset:6144
    ds_write_b128 v164, v[60:63] offset:7168
    ds_write_b128 v164, v[64:67] offset:8192
    ds_write_b128 v164, v[68:71] offset:9216
    ds_write_b128 v164, v[72:75] offset:10240
    ds_write_b128 v164, v[76:79] offset:11264
    ds_write_b128 v164, v[80:83] offset:12288
    ds_write_b128 v164, v[84:87] offset:13312
    ds_write_b128 v164, v[88:91] offset:14336
    ds_write_b128 v164, v[92:95] offset:15360
    s_waitcnt lgkmcnt(0)
    s_lshl_b32 s48, s59, 2
    s_add_u32 s31, s48, 135232
    v_mov_b32 v3, s31
    v_mov_b32 v4, 1
    s_mov_b64 exec, 1
    ds_add_u32 v3, v4
    s_mov_b64 exec, -1
    s_mov_b32 s55, 4000
gated_mix__softmax_full_mha__spectral_fnet__prompt_kernel_oload:
    s_add_u32 s49, s30, 0
    buffer_load_dwordx4 v[32:35], v2, s[32:35], s49 offen sc1
    s_add_u32 s49, s30, 1024
    buffer_load_dwordx4 v[36:39], v2, s[32:35], s49 offen sc1
    s_add_u32 s49, s30, 2048
    buffer_load_dwordx4 v[40:43], v2, s[32:35], s49 offen sc1
    s_add_u32 s49, s30, 3072
    buffer_load_dwordx4 v[44:47], v2, s[32:35], s49 offen sc1
    s_add_u32 s49, s30, 4096
    buffer_load_dwordx4 v[48:51], v2, s[32:35], s49 offen sc1
    s_add_u32 s49, s30, 5120
    buffer_load_dwordx4 v[52:55], v2, s[32:35], s49 offen sc1
    s_add_u32 s49, s30, 6144
    buffer_load_dwordx4 v[56:59], v2, s[32:35], s49 offen sc1
    s_add_u32 s49, s30, 7168
    buffer_load_dwordx4 v[60:63], v2, s[32:35], s49 offen sc1
    s_add_u32 s49, s30, 8192
    buffer_load_dwordx4 v[64:67], v2, s[32:35], s49 offen sc1
    s_add_u32 s49, s30, 9216
    buffer_load_dwordx4 v[68:71], v2, s[32:35], s49 offen sc1
    s_add_u32 s49, s30, 10240
    buffer_load_dwordx4 v[72:75], v2, s[32:35], s49 offen sc1
    s_add_u32 s49, s30, 11264
    buffer_load_dwordx4 v[76:79], v2, s[32:35], s49 offen sc1
    s_add_u32 s49, s30, 12288
    buffer_load_dwordx4 v[80:83], v2, s[32:35], s49 offen sc1
    s_add_u32 s49, s30, 13312
    buffer_load_dwordx4 v[84:87], v2, s[32:35], s49 offen sc1
    s_add_u32 s49, s30, 14336
    buffer_load_dwordx4 v[88:91], v2, s[32:35], s49 offen sc1
    s_add_u32 s49, s30, 15360
    buffer_load_dwordx4 v[92:95], v2, s[32:35], s49 offen sc1
    v_mov_b32 v12, 0
    s_waitcnt vmcnt(15)
    v_max3_u32 v12, v12, v32, v33
    v_max3_u32 v12, v12, v34, v35
    s_waitcnt vmcnt(14)
    v_max3_u32 v12, v12, v36, v37
    v_max3_u32 v12, v12, v38, v39
    s_waitcnt vmcnt(13)
    v_max3_u32 v12, v12, v40, v41
    v_max3_u32 v12, v12, v42, v43
    s_waitcnt vmcnt(12)
    v_max3_u32 v12, v12, v44, v45
    v_max3_u32 v12, v12, v46, v47
    s_waitcnt vmcnt(11)
    v_max3_u32 v12, v12, v48, v49
    v_max3_u32 v12, v12, v50, v51
    s_waitcnt vmcnt(10)
    v_max3_u32 v12, v12, v52, v53
    v_max3_u32 v12, v12, v54, v55
    s_waitcnt vmcnt(9)
    v_max3_u32 v12, v12, v56, v57
    v_max3_u32 v12, v12, v58, v59
    s_waitcnt vmcnt(8)
    v_max3_u32 v12, v12, v60, v61
    v_max3_u32 v12, v12, v62, v63
    s_waitcnt vmcnt(7)
    v_max3_u32 v12, v12, v64, v65
    v_max3_u32 v12, v12, v66, v67
    s_waitcnt vmcnt(6)
    v_max3_u32 v12, v12, v68, v69
    v_max3_u32 v12, v12, v70, v71
    s_waitcnt vmcnt(5)
    v_max3_u32 v12, v12, v72, v73
    v_max3_u32 v12, v12, v74, v75
    s_waitcnt vmcnt(4)
    v_max3_u32 v12, v12, v76, v77
    v_max3_u32 v12, v12, v78, v79
    s_waitcnt vmcnt(3)
    v_max3_u32 v12, v12, v80, v81
    v_max3_u32 v12, v12, v82, v83
    s_waitcnt vmcnt(2)
    v_max3_u32 v12, v12, v84, v85
    v_max3_u32 v12, v12, v86, v87
    s_waitcnt vmcnt(1)
    v_max3_u32 v12, v12, v88, v89
    v_max3_u32 v12, v12, v90, v91
    s_waitcnt vmcnt(0)
    v_max3_u32 v12, v12, v92, v93
    v_max3_u32 v12, v12, v94, v95
    v_cmp_eq_u32 vcc, -1, v12
    s_nop 4
    s_cbranch_vccz gated_mix__softmax_full_mha__spectral_fnet__prompt_kernel_ogood
    s_sub_u32 s55, s55, 1
    s_cbranch_scc0 gated_mix__softmax_full_mha__spectral_fnet__prompt_kernel_oload
gated_mix__softmax_full_mha__spectral_fnet__prompt_kernel_ogood:
    v_mov_b32 v3, s31
    s_mov_b32 s51, 1048576
gated_mix__softmax_full_mha__spectral_fnet__prompt_kernel_cw4:
    ds_read_b32 v4, v3
    s_waitcnt lgkmcnt(0)
    v_readfirstlane_b32 s48, v4
    s_sub_u32 s51, s51, 1
    s_cbranch_scc1 gated_mix__softmax_full_mha__spectral_fnet__prompt_kernel_cw4_ok
    s_nop 1
    s_cmp_ge_u32 s48, 2
    s_cbranch_scc1 gated_mix__softmax_full_mha__spectral_fnet__prompt_kernel_cw4_ok
    s_branch gated_mix__softmax_full_mha__spectral_fnet__prompt_kernel_cw4
gated_mix__softmax_full_mha__spectral_fnet__prompt_kernel_cw4_ok:
    ds_read_b64_tr_b16 v[96:97], v160 offset:0
    ds_read_b64_tr_b16 v[98:99], v160 offset:1024
    ds_read_b64_tr_b16 v[100:101], v161 offset:0
    ds_read_b64_tr_b16 v[102:103], v161 offset:1024
    ds_read_b64_tr_b16 v[104:105], v160 offset:2048
    ds_read_b64_tr_b16 v[106:107], v160 offset:3072
    ds_read_b64_tr_b16 v[108:109], v161 offset:2048
    ds_read_b64_tr_b16 v[110:111], v161 offset:3072
    ds_read_b64_tr_b16 v[112:113], v160 offset:4096
    ds_read_b64_tr_b16 v[114:115], v160 offset:5120
    ds_read_b64_tr_b16 v[116:117], v161 offset:4096
    ds_read_b64_tr_b16 v[118:119], v161 offset:5120
    s_waitcnt lgkmcnt(8)
    v_mfma_f32_32x32x16_bf16 v[120:135], v[96:99], v[32:35], 0
    v_mfma_f32_32x32x16_bf16 v[136:151], v[100:103], v[32:35], 0
    ds_read_b64_tr_b16 v[96:97], v160 offset:6144
    ds_read_b64_tr_b16 v[98:99], v160 offset:7168
    ds_read_b64_tr_b16 v[100:101], v161 offset:6144
    ds_read_b64_tr_b16 v[102:103], v161 offset:7168
    s_waitcnt lgkmcnt(8)
    v_mfma_f32_32x32x16_bf16 v[120:135], v[104:107], v[36:39], v[120:135]
    v_mfma_f32_32x32x16_bf16 v[136:151], v[108:111], v[36:39], v[136:151]
    ds_read_b64_tr_b16 v[104:105], v160 offset:8192
    ds_read_b64_tr_b16 v[106:107], v160 offset:9216
    ds_read_b64_tr_b16 v[108:109], v161 offset:8192
    ds_read_b64_tr_b16 v[110:111], v161 offset:9216
    s_waitcnt lgkmcnt(8)
    v_mfma_f32_32x32x16_bf16 v[120:135], v[112:115], v[40:43], v[120:135]
    v_mfma_f32_32x32x16_bf16 v[136:151], v[116:119], v[40:43], v[136:151]
    ds_read_b64_tr_b16 v[112:113], v160 offset:10240
    ds_read_b64_tr_b16 v[114:115], v160 offset:11264
    ds_read_b64_tr_b16 v[116:117], v161 offset:10240
    ds_read_b64_tr_b16 v[118:119], v161 offset:11264
    s_waitcnt lgkmcnt(8)
    v_mfma_f32_32x32x16_bf16 v[120:135], v[96:99], v[44:47], v[120:135]
    v_mfma_f32_32x32x16_bf16 v[136:151], v[100:103], v[44:47], v[136:151]
    ds_read_b64_tr_b16 v[96:97], v160 offset:12288
    ds_read_b64_tr_b16 v[98:99], v160 offset:13312
    ds_read_b64_tr_b16 v[100:101], v161 offset:12288
    ds_read_b64_tr_b16 v[102:103], v161 offset:13312
    s_waitcnt lgkmcnt(8)
    v_mfma_f32_32x32x16_bf16 v[120:135], v[104:107], v[48:51], v[120:135]
    v_mfma_f32_32x32x16_bf16 v[136:151], v[108:111], v[48:51], v[136:151]
    ds_read_b64_tr_b16 v[104:105], v160 offset:14336
    ds_read_b64_tr_b16 v[106:107], v160 offset:15360
    ds_read_b64_tr_b16 v[108:109], v161 offset:14336
    ds_read_b64_tr_b16 v[110:111], v161 offset:15360
    s_waitcnt lgkmcnt(8)
    v_mfma_f32_32x32x16_bf16 v[120:135], v[112:115], v[52:55], v[120:135]
    v_mfma_f32_32x32x16_bf16 v[136:151], v[116:119], v[52:55], v[136:151]
    ds_read_b64_tr_b16 v[112:113], v160 offset:16384
    ds_read_b64_tr_b16 v[114:115], v160 offset:17408
    ds_read_b64_tr_b16 v[116:117], v161 offset:16384
    ds_read_b64_tr_b16 v[118:119], v161 offset:17408
    s_waitcnt lgkmcnt(8)
    v_mfma_f32_32x32x16_bf16 v[120:135], v[96:99], v[56:59], v[120:135]
    v_mfma_f32_32x32x16_bf16 v[136:151], v[100:103], v[56:59], v[136:151]
    ds_read_b64_tr_b16 v[96:97], v160 offset:18432
    ds_read_b64_tr_b16 v[98:99], v160 offset:19456
    ds_read_b64_tr_b16 v[100:101], v161 offset:18432
    ds_read_b64_tr_b16 v[102:103], v161 offset:19456
    s_waitcnt lgkmcnt(8)
    v_mfma_f32_32x32x16_bf16 v[120:135], v[104:107], v[60:63], v[120:135]
    v_mfma_f32_32x32x16_bf16 v[136:151], v[108:111], v[60:63], v[136:151]
    ds_read_b64_tr_b16 v[104:105], v160 offset:20480
    ds_read_b64_tr_b16 v[106:107], v160 offset:21504
    ds_read_b64_tr_b16 v[108:109], v161 offset:20480
    ds_read_b64_tr_b16 v[110:111], v161 offset:21504
    s_waitcnt lgkmcnt(8)
    v_mfma_f32_32x32x16_bf16 v[120:135], v[112:115], v[64:67], v[120:135]
    v_mfma_f32_32x32x16_bf16 v[136:151], v[116:119], v[64:67], v[136:151]
    ds_read_b64_tr_b16 v[112:113], v160 offset:22528
    ds_read_b64_tr_b16 v[114:115], v160 offset:23552
    ds_read_b64_tr_b16 v[116:117], v161 offset:22528
    ds_read_b64_tr_b16 v[118:119], v161 offset:23552
    s_waitcnt lgkmcnt(8)
    v_mfma_f32_32x32x16_bf16 v[120:135], v[96:99], v[68:71], v[120:135]
    v_mfma_f32_32x32x16_bf16 v[136:151], v[100:103], v[68:71], v[136:151]
    ds_read_b64_tr_b16 v[96:97], v160 offset:24576
    ds_read_b64_tr_b16 v[98:99], v160 offset:25600
    ds_read_b64_tr_b16 v[100:101], v161 offset:24576
    ds_read_b64_tr_b16 v[102:103], v161 offset:25600
    s_waitcnt lgkmcnt(8)
    v_mfma_f32_32x32x16_bf16 v[120:135], v[104:107], v[72:75], v[120:135]
    v_mfma_f32_32x32x16_bf16 v[136:151], v[108:111], v[72:75], v[136:151]
    ds_read_b64_tr_b16 v[104:105], v160 offset:26624
    ds_read_b64_tr_b16 v[106:107], v160 offset:27648
    ds_read_b64_tr_b16 v[108:109], v161 offset:26624
    ds_read_b64_tr_b16 v[110:111], v161 offset:27648
    s_waitcnt lgkmcnt(8)
    v_mfma_f32_32x32x16_bf16 v[120:135], v[112:115], v[76:79], v[120:135]
    v_mfma_f32_32x32x16_bf16 v[136:151], v[116:119], v[76:79], v[136:151]
    ds_read_b64_tr_b16 v[112:113], v160 offset:28672
    ds_read_b64_tr_b16 v[114:115], v160 offset:29696
    ds_read_b64_tr_b16 v[116:117], v161 offset:28672
    ds_read_b64_tr_b16 v[118:119], v161 offset:29696
    s_waitcnt lgkmcnt(8)
    v_mfma_f32_32x32x16_bf16 v[120:135], v[96:99], v[80:83], v[120:135]
    v_mfma_f32_32x32x16_bf16 v[136:151], v[100:103], v[80:83], v[136:151]
    ds_read_b64_tr_b16 v[96:97], v160 offset:30720
    ds_read_b64_tr_b16 v[98:99], v160 offset:31744
    ds_read_b64_tr_b16 v[100:101], v161 offset:30720
    ds_read_b64_tr_b16 v[102:103], v161 offset:31744
    s_waitcnt lgkmcnt(8)
    v_mfma_f32_32x32x16_bf16 v[120:135], v[104:107], v[84:87], v[120:135]
    v_mfma_f32_32x32x16_bf16 v[136:151], v[108:111], v[84:87], v[136:151]
    s_waitcnt lgkmcnt(4)
    v_mfma_f32_32x32x16_bf16 v[120:135], v[112:115], v[88:91], v[120:135]
    v_mfma_f32_32x32x16_bf16 v[136:151], v[116:119], v[88:91], v[136:151]
    s_waitcnt lgkmcnt(0)
    v_mfma_f32_32x32x16_bf16 v[120:135], v[96:99], v[92:95], v[120:135]
    v_mfma_f32_32x32x16_bf16 v[136:151], v[100:103], v[92:95], v[136:151]
gated_mix__softmax_full_mha__spectral_fnet__prompt_kernel_ook:
    s_nop 15
    s_lshl_b32 s48, s54, 12
    s_add_u32 s48, s48, 65536
    v_add_u32 v3, s48, v2
    s_cmp_eq_u32 s59, 0
    s_cbranch_scc0 gated_mix__softmax_full_mha__spectral_fnet__prompt_kernel_y1
    ds_write_b128 v3, v[136:139] offset:0
    ds_write_b128 v3, v[140:143] offset:1024
    ds_write_b128 v3, v[144:147] offset:2048
    ds_write_b128 v3, v[148:151] offset:3072
    s_branch gated_mix__softmax_full_mha__spectral_fnet__prompt_kernel_y2
gated_mix__softmax_full_mha__spectral_fnet__prompt_kernel_y1:
    ds_write_b128 v3, v[120:123] offset:0
    ds_write_b128 v3, v[124:127] offset:1024
    ds_write_b128 v3, v[128:131] offset:2048
    ds_write_b128 v3, v[132:135] offset:3072
    v_mov_b32 v120, v136
    v_mov_b32 v121, v137
    v_mov_b32 v122, v138
    v_mov_b32 v123, v139
    v_mov_b32 v124, v140
    v_mov_b32 v125, v141
    v_mov_b32 v126, v142
    v_mov_b32 v127, v143
    v_mov_b32 v128, v144
    v_mov_b32 v129, v145
    v_mov_b32 v130, v146
    v_mov_b32 v131, v147
    v_mov_b32 v132, v148
    v_mov_b32 v133, v149
    v_mov_b32 v134, v150
    v_mov_b32 v135, v151
gated_mix__softmax_full_mha__spectral_fnet__prompt_kernel_y2:
    s_waitcnt lgkmcnt(0)
    s_lshl_b32 s48, s58, 2
    s_add_u32 s31, s48, 135240
    v_mov_b32 v4, s31
    v_mov_b32 v5, 1
    s_mov_b64 exec, 1
    ds_add_u32 v4, v5
    s_mov_b64 exec, -1
    v_mov_b32 v4, s31
    s_mov_b32 s51, 1048576
gated_mix__softmax_full_mha__spectral_fnet__prompt_kernel_cw5:
    ds_read_b32 v5, v4
    s_waitcnt lgkmcnt(0)
    v_readfirstlane_b32 s48, v5
    s_sub_u32 s51, s51, 1
    s_cbranch_scc1 gated_mix__softmax_full_mha__spectral_fnet__prompt_kernel_cw5_ok
    s_nop 1
    s_cmp_ge_u32 s48, 2
    s_cbranch_scc1 gated_mix__softmax_full_mha__spectral_fnet__prompt_kernel_cw5_ok
    s_branch gated_mix__softmax_full_mha__spectral_fnet__prompt_kernel_cw5
gated_mix__softmax_full_mha__spectral_fnet__prompt_kernel_cw5_ok:
    s_xor_b32 s48, s54, 2
    s_lshl_b32 s48, s48, 12
    s_add_u32 s48, s48, 65536
    v_add_u32 v3, s48, v2
    ds_read_b128 v[32:35], v3 offset:0
    ds_read_b128 v[36:39], v3 offset:1024
    ds_read_b128 v[40:43], v3 offset:2048
    ds_read_b128 v[44:47], v3 offset:3072
    s_waitcnt lgkmcnt(0)
    v_add_f32 v120, v120, v32
    v_add_f32 v121, v121, v33
    v_add_f32 v122, v122, v34
    v_add_f32 v123, v123, v35
    v_add_f32 v124, v124, v36
    v_add_f32 v125, v125, v37
    v_add_f32 v126, v126, v38
    v_add_f32 v127, v127, v39
    v_add_f32 v128, v128, v40
    v_add_f32 v129, v129, v41
    v_add_f32 v130, v130, v42
    v_add_f32 v131, v131, v43
    v_add_f32 v132, v132, v44
    v_add_f32 v133, v133, v45
    v_add_f32 v134, v134, v46
    v_add_f32 v135, v135, v47
    s_cmp_eq_u32 s62, 0
    s_cbranch_scc0 gated_mix__softmax_full_mha__spectral_fnet__prompt_kernel_cm
    v_sub_f32 v120, v120, v16
    v_fma_f32 v120, v9, v120, v16
    v_sub_f32 v121, v121, v17
    v_fma_f32 v121, v9, v121, v17
    v_sub_f32 v122, v122, v18
    v_fma_f32 v122, v9, v122, v18
    v_sub_f32 v123, v123, v19
    v_fma_f32 v123, v9, v123, v19
    v_sub_f32 v124, v124, v20
    v_fma_f32 v124, v9, v124, v20
    v_sub_f32 v125, v125, v21
    v_fma_f32 v125, v9, v125, v21
    v_sub_f32 v126, v126, v22
    v_fma_f32 v126, v9, v126, v22
    v_sub_f32 v127, v127, v23
    v_fma_f32 v127, v9, v127, v23
    v_sub_f32 v128, v128, v24
    v_fma_f32 v128, v9, v128, v24
    v_sub_f32 v129, v129, v25
    v_fma_f32 v129, v9, v129, v25
    v_sub_f32 v130, v130, v26
    v_fma_f32 v130, v9, v130, v26
    v_sub_f32 v131, v131, v27
    v_fma_f32 v131, v9, v131, v27
    v_sub_f32 v132, v132, v28
    v_fma_f32 v132, v9, v132, v28
    v_sub_f32 v133, v133, v29
    v_fma_f32 v133, v9, v133, v29
    v_sub_f32 v134, v134, v30
    v_fma_f32 v134, v9, v134, v30
    v_sub_f32 v135, v135, v31
    v_fma_f32 v135, v9, v135, v31
    s_branch gated_mix__softmax_full_mha__spectral_fnet__prompt_kernel_st
gated_mix__softmax_full_mha__spectral_fnet__prompt_kernel_cm:
    v_sub_f32 v120, v120, v31
    v_fma_f32 v120, v9, v120, v31
    v_sub_f32 v121, v121, v30
    v_fma_f32 v121, v9, v121, v30
    v_sub_f32 v122, v122, v29
    v_fma_f32 v122, v9, v122, v29
    v_sub_f32 v123, v123, v28
    v_fma_f32 v123, v9, v123, v28
    v_sub_f32 v124, v124, v27
    v_fma_f32 v124, v9, v124, v27
    v_sub_f32 v125, v125, v26
    v_fma_f32 v125, v9, v125, v26
    v_sub_f32 v126, v126, v25
    v_fma_f32 v126, v9, v126, v25
    v_sub_f32 v127, v127, v24
    v_fma_f32 v127, v9, v127, v24
    v_sub_f32 v128, v128, v23
    v_fma_f32 v128, v9, v128, v23
    v_sub_f32 v129, v129, v22
    v_fma_f32 v129, v9, v129, v22
    v_sub_f32 v130, v130, v21
    v_fma_f32 v130, v9, v130, v21
    v_sub_f32 v131, v131, v20
    v_fma_f32 v131, v9, v131, v20
    v_sub_f32 v132, v132, v19
    v_fma_f32 v132, v9, v132, v19
    v_sub_f32 v133, v133, v18
    v_fma_f32 v133, v9, v133, v18
    v_sub_f32 v134, v134, v17
    v_fma_f32 v134, v9, v134, v17
    v_sub_f32 v135, v135, v16
    v_fma_f32 v135, v9, v135, v16
gated_mix__softmax_full_mha__spectral_fnet__prompt_kernel_st:
    v_cvt_pk_bf16_f32 v48, v120, v121
    v_cvt_pk_bf16_f32 v49, v122, v123
    v_cvt_pk_bf16_f32 v50, v124, v125
    v_cvt_pk_bf16_f32 v51, v126, v127
    v_cvt_pk_bf16_f32 v52, v128, v129
    v_cvt_pk_bf16_f32 v53, v130, v131
    v_cvt_pk_bf16_f32 v54, v132, v133
    v_cvt_pk_bf16_f32 v55, v134, v135
    v_and_b32 v3, 31, v1
    v_add_u32 v3, s60, v3
    v_lshlrev_b32 v3, 10, v3
    v_lshrrev_b32 v4, 5, v1
    v_lshlrev_b32 v4, 4, v4
    v_add_u32 v3, v3, v4
    s_lshl_b32 s48, s61, 1
    v_permlane32_swap_b32 v48, v50
    v_permlane32_swap_b32 v49, v51
    v_permlane32_swap_b32 v52, v54
    v_permlane32_swap_b32 v53, v55
    buffer_store_dwordx4 v[48:51], v3, s[36:39], s48 offen offset:0
    buffer_store_dwordx4 v[52:55], v3, s[36:39], s48 offen offset:32
    s_endpgm
gated_mix__softmax_full_mha__spectral_fnet__prompt_kernel_end:
    s_endpgm
.section .rodata,"a"
.p2align 6
.amdhsa_kernel gated_mix__softmax_full_mha__spectral_fnet__prompt_kernel
  .amdhsa_next_free_vgpr 165
  .amdhsa_next_free_sgpr 102
  .amdhsa_accum_offset 168
  .amdhsa_group_segment_fixed_size 0
  .amdhsa_kernarg_size 96
  .amdhsa_user_sgpr_count 2
  .amdhsa_user_sgpr_kernarg_segment_ptr 1
  .amdhsa_system_sgpr_workgroup_id_x 1
.end_amdhsa_kernel
```
